```python
import torch

def _softmax(x, axis=-1):
    return torch.softmax(x, dim=axis)

def _gelu(x):
    return torch.nn.functional.gelu(x, approximate='tanh')

def _silu(x):
    return torch.nn.functional.silu(x)

def _sigmoid(x):
    return torch.sigmoid(x)

def _layernorm(x, axis=-1, eps=1e-05):
    m = x.mean(dim=axis, keepdim=True)
    v = x.var(dim=axis, keepdim=True, unbiased=False)
    return (x - m) / torch.sqrt(v + eps)

def _scatter_add(tgt, idx, src, axis=0):
    return tgt.clone().index_add_(axis, idx, src)

def _segment_sum(src, seg, n):
    out = torch.zeros((n,) + src.shape[1:], dtype=src.dtype)
    return out.index_add_(0, seg, src)

def _pad(x, pw):
    flat = tuple((v for pair in reversed(pw) for v in pair))
    return torch.nn.functional.pad(x, flat)
kernel_name = 'adaLN_cond__gqa_block_cached__geglu_ffn__decode'

def setup_inputs():

    _w = lambda a: (lambda t: t.to(torch.bfloat16) if t.is_floating_point() else t)(torch.as_tensor(a))

    def _A_setup():
        B, Sq, D = (1, 1, 512)
        Hq, Hkv, Sk, Dh = (32, 8, 65536, 128)
        assert Hq % Hkv == 0, (Hq, Hkv)
        return {'x': _w((lambda *s: torch.randn(*s, dtype=torch.bfloat16) * 0.05)(B, Sq, D)), 'k_cache': _w((lambda *s: torch.randn(*s, dtype=torch.bfloat16) * 3.2)(B, Hkv, Sk, Dh)), 'v_cache': _w((lambda *s: torch.randn(*s, dtype=torch.bfloat16) * 0.4)(B, Hkv, Sk, Dh)), 'wq': _w((lambda *s: torch.randn(*s, dtype=torch.bfloat16) * 3.2)(D, Hq * Dh) * D ** (-0.5)), 'wo': _w((lambda *s: torch.randn(*s, dtype=torch.bfloat16) * 0.4)(Hq * Dh, D) * (Hq * Dh) ** (-0.5))}
    _A_in = _A_setup()

    def _B_setup():
        B, S, D, F = (1, 1, 512, 1792)
        return {'x': _w((lambda *s: torch.randn(*s, dtype=torch.bfloat16) * 0.05)(B, S, D)), 'w_gate': _w((lambda *s: torch.randn(*s, dtype=torch.bfloat16) * 0.05)(D, F)), 'w_up': _w((lambda *s: torch.randn(*s, dtype=torch.bfloat16) * 0.05)(D, F)), 'w_down': _w((lambda *s: torch.randn(*s, dtype=torch.bfloat16) * 0.05)(F, D))}
    _B_in = _B_setup()
    return {'A_x': _A_in['x'], 'A_k_cache': _A_in['k_cache'], 'A_v_cache': _A_in['v_cache'], 'A_wq': _A_in['wq'], 'A_wo': _A_in['wo'], 'B_x': _B_in['x'], 'B_w_gate': _B_in['w_gate'], 'B_w_up': _B_in['w_up'], 'B_w_down': _B_in['w_down'], 'c': _w((lambda *s: torch.randn(*s, dtype=torch.bfloat16) * 0.2)(1, 512) * 8.0), 'w_mod': _w((lambda *s: torch.randn(*s, dtype=torch.bfloat16) * 0.2)(512, 6 * 512) * 512 ** (-0.5) * 8.0)}

def reference(A_x, A_k_cache, A_v_cache, A_wq, A_wo, B_x, B_w_gate, B_w_up, B_w_down, c, w_mod):

    def _A_ref(x, k_cache, v_cache, wq, wo):
        B, Sq, D = x.shape
        Hq, Dh = (32, 128)
        Hkv = k_cache.shape[1]
        rep = Hq // Hkv
        q = (lambda x, *d: x.permute(*d))((x @ wq).reshape(B, Sq, Hq, Dh), 0, 2, 1, 3)
        k = (lambda x, n, axis: torch.repeat_interleave(x, n, dim=axis))(k_cache, rep, axis=1)
        v = (lambda x, n, axis: torch.repeat_interleave(x, n, dim=axis))(v_cache, rep, axis=1)
        scores = torch.einsum('bhqd,bhkd->bhqk', q, k) * Dh ** (-0.5)
        p = _softmax(scores, axis=-1)
        o = torch.einsum('bhqk,bhkd->bhqd', p, v)
        return (lambda x, *d: x.permute(*d))(o, 0, 2, 1, 3).reshape(B, Sq, Hq * Dh) @ wo

    def _B_ref(x, w_gate, w_up, w_down):
        return _gelu(x @ w_gate) * (x @ w_up) @ w_down
    x = A_x
    mod = (_silu(c) @ w_mod).reshape(c.shape[0], 6, 1, -1)
    sa, ca, ga, sb, cb, gb = (mod[:, 0].clone(), mod[:, 1].clone(), mod[:, 2].clone(), mod[:, 3].clone(), mod[:, 4].clone(), mod[:, 5].clone())
    h = _layernorm(x, axis=-1) * (1 + ca) + sa
    x = x + ga * _A_ref(h, A_k_cache, A_v_cache, A_wq, A_wo)
    h = _layernorm(x, axis=-1) * (1 + cb) + sb
    x = x + gb * _B_ref(h, B_w_gate, B_w_up, B_w_down)
    return x
```

```asm
; @launch grid=(256,1,1) block=(512,1,1) lds=157696
.amdgcn_target "amdgcn-amd-amdhsa--gfx950"
.text
.globl adaLN_cond__gqa_block_cached__geglu_ffn__decode_kernel
.p2align 12
.type adaLN_cond__gqa_block_cached__geglu_ffn__decode_kernel,@function
adaLN_cond__gqa_block_cached__geglu_ffn__decode_kernel:
  s_cmp_ge_u32 s2, 256
  s_cbranch_scc1 L_end
  s_load_dwordx2 s[32:33], s[0:1], 8
  s_load_dwordx2 s[36:37], s[0:1], 16
  s_load_dwordx2 s[40:41], s[0:1], 104
  s_load_dwordx16 s[4:19], s[0:1], 0
  s_load_dwordx8 s[20:27], s[0:1], 64
  s_mov_b32 s94, 1
  v_lshrrev_b32 v9, 6, v0
  v_and_b32 v1, 63, v0
  v_mov_b32 v94, 0
  v_mov_b32 v88, 0
  v_readfirstlane_b32 s3, v9
  v_lshlrev_b32 v3, 4, v1
  s_and_b32 s58, s2, 7
  s_lshr_b32 s59, s2, 3
  s_lshl_b32 s53, s58, 24
  s_lshl_b32 s54, s59, 19
  s_add_u32 s54, s54, s53
  s_mov_b32 s34, 0x8000000
  s_mov_b32 s35, 0x20000
  s_mov_b32 s38, 0x8000000
  s_mov_b32 s39, 0x20000
  s_mov_b32 s42, 0x20000000
  s_mov_b32 s43, 0x20000
  s_mov_b32 s47, 0x20000
  s_mov_b32 s98, 6400000
  s_cmp_lg_u32 s3, 0
  s_cbranch_scc1 L_nl
  s_setprio 3
  v_lshlrev_b32 v9, 3, v1
  v_mov_b32 v10, 0
  v_mov_b32 v11, 0
  ds_write_b64 v9, v[10:11] offset:15616
  v_mov_b32 v18, 15888
  v_mov_b32 v16, 2147483647
  v_mov_b32 v17, 4
  ds_write_b64 v18, v[16:17]
  v_lshlrev_b32 v9, 2, v1
  v_lshlrev_b32 v10, 13, v1
  v_add_u32 v10, s54, v10
  v_cmp_gt_u32 vcc, 40, v1
  v_mov_b32 v12, s54
  s_mov_b32 s76, 22528
  v_cndmask_b32 v10, -1, v10, vcc
  s_mov_b32 s77, 0
  ds_write_b32 v9, v10 offset:22016
  s_mov_b32 s78, -7
  s_mov_b32 s81, 0
  s_mov_b32 s87, 1
  v_mov_b32 v14, 15936
  v_mov_b32 v13, 22016
  s_cmp_ge_u32 s58, 4
  s_mov_b32 s28, 2290649190
  s_mov_b32 s29, 286868616
  s_cselect_b32 s29, 1145324680, s29
  s_mov_b32 s30, 1431655765
  s_mov_b32 s31, 286333337
  s_cselect_b32 s31, 268437913, s31
  v_and_b32 v22, 0xff, v3
  v_bfe_u32 v23, v1, 4, 1
  v_lshl_add_u32 v22, v23, 9, v22
  v_lshrrev_b32 v23, 5, v1
  v_lshl_add_u32 v22, v23, 13, v22
  s_cmp_ge_u32 s2, 80
  s_cbranch_scc1 L_pro
  s_mov_b32 s87, 3
  v_mov_b32 v19, 15884
  s_waitcnt lgkmcnt(0)
  s_barrier
L_cw:
  ds_read_b32 v10, v19
  s_sub_u32 s98, s98, 1
  s_waitcnt lgkmcnt(0)
  v_readfirstlane_b32 s62, v10
  s_nop 0
  s_cmp_ge_u32 s62, 4
  s_nop 1
  s_cbranch_scc1 L_pro
  s_sleep 1
  s_cmp_gt_u32 s98, 3200000
  s_cbranch_scc1 L_cw
L_pro:
  s_add_u32 s99, s54, 8192
  s_bitcmp1_b32 s54, 23
  s_cselect_b64 s[56:57], s[30:31], s[28:29]
  s_bfe_u32 s55, s54, 262163
  s_lshl_b32 s55, s55, 2
  s_lshr_b64 s[56:57], s[56:57], s55
  s_and_b32 s56, s56, 15
  s_lshl_b32 s56, s56, 13
  s_add_u32 s56, s56, s54
  s_andn2_b32 s54, s54, 0x7ffff
  s_bfe_u32 s55, s56, 65549
  s_lshl_b32 s55, s55, 8
  s_or_b32 s54, s54, s55
  s_bfe_u32 s55, s56, 327694
  s_lshl_b32 s55, s55, 14
  s_or_b32 s54, s54, s55
  s_waitcnt lgkmcnt(0)
  s_add_u32 m0, s76, 0
  s_add_u32 s55, s54, 0
  buffer_load_dwordx4 v22, s[32:35], s55 offen nt lds
  s_add_u32 m0, s76, 1056
  s_add_u32 s55, s54, 1024
  buffer_load_dwordx4 v22, s[32:35], s55 offen nt lds
  s_add_u32 m0, s76, 2112
  s_add_u32 s55, s54, 2048
  buffer_load_dwordx4 v22, s[32:35], s55 offen nt lds
  s_add_u32 m0, s76, 3168
  s_add_u32 s55, s54, 3072
  buffer_load_dwordx4 v22, s[32:35], s55 offen nt lds
  s_add_u32 s80, s76, 16896
  v_add_u32 v14, 4, v14
  v_add_u32 v13, 4, v13
  s_cmp_eq_u32 s80, 157696
  s_cselect_b32 s80, 22528, s80
  v_and_b32 v14, 15967, v14
  s_add_u32 m0, s76, 4224
  s_add_u32 s55, s54, 4096
  buffer_load_dwordx4 v22, s[32:35], s55 offen nt lds
  s_add_u32 m0, s76, 5280
  s_add_u32 s55, s54, 5120
  buffer_load_dwordx4 v22, s[32:35], s55 offen nt lds
  s_add_u32 m0, s76, 6336
  s_add_u32 s55, s54, 6144
  buffer_load_dwordx4 v22, s[32:35], s55 offen nt lds
  s_add_u32 m0, s76, 7392
  s_add_u32 s55, s54, 7168
  buffer_load_dwordx4 v22, s[32:35], s55 offen nt lds
  ds_read_b32 v11, v14
  ds_read_b32 v12, v13
  s_mov_b32 s84, s86
  s_mov_b32 s85, s89
  s_mov_b32 s86, s54
  s_mov_b32 s89, s76
  s_mov_b32 s76, s80
  s_add_u32 s77, s77, 1
  s_add_u32 s78, s78, 1
  s_mov_b32 s54, s99
  s_cmp_lt_u32 s77, 2
  s_cbranch_scc1 L_pro
  s_branch L_lsp
L_ld:
  s_lshl_b32 s79, s77, 1
  s_sub_u32 s79, s79, 2
  s_waitcnt lgkmcnt(0)
  v_readfirstlane_b32 s62, v11
  v_readfirstlane_b32 s54, v12
  v_readfirstlane_b32 s83, v17
  s_cmp_lt_i32 s62, s78
  s_nop 2
  s_cbranch_scc1 L_ld_spin
  s_cmp_lt_i32 s54, 0
  s_cbranch_scc1 L_ld_spin
  s_bitcmp1_b32 s54, 23
  s_cselect_b64 s[56:57], s[30:31], s[28:29]
  s_bfe_u32 s55, s54, 262163
  s_lshl_b32 s55, s55, 2
  s_lshr_b64 s[56:57], s[56:57], s55
  s_and_b32 s56, s56, 15
  s_lshl_b32 s56, s56, 13
  s_add_u32 s56, s56, s54
  s_andn2_b32 s54, s54, 0x7ffff
  s_bfe_u32 s55, s56, 65549
  s_lshl_b32 s55, s55, 8
  s_or_b32 s54, s54, s55
  s_bfe_u32 s55, s56, 327694
  s_lshl_b32 s55, s55, 14
  s_or_b32 s54, s54, s55
  s_add_u32 s55, s54, 4096
  s_mov_b32 s82, 0
  s_cmp_lg_u32 s83, 4
  s_cbranch_scc1 L_tree
  s_add_u32 m0, s76, 0
  s_add_u32 s55, s54, 0
  buffer_load_dwordx4 v22, s[32:35], s55 offen nt lds
  s_waitcnt vmcnt(21)
  s_add_u32 m0, s76, 1056
  s_add_u32 s55, s54, 1024
  buffer_load_dwordx4 v22, s[32:35], s55 offen nt lds
  s_waitcnt vmcnt(21)
  s_add_u32 m0, s76, 2112
  s_add_u32 s55, s54, 2048
  buffer_load_dwordx4 v22, s[32:35], s55 offen nt lds
  s_waitcnt vmcnt(21)
  s_add_u32 m0, s76, 3168
  s_add_u32 s55, s54, 3072
  buffer_load_dwordx4 v22, s[32:35], s55 offen nt lds
  s_waitcnt vmcnt(21)
  s_add_u32 m0, s76, 4224
  s_add_u32 s55, s54, 4096
  buffer_load_dwordx4 v22, s[32:35], s55 offen nt lds
  s_add_u32 s62, s79, -2
  s_max_i32 s81, s81, s62
  v_mov_b32 v10, s81
  s_waitcnt vmcnt(21)
  ds_write_b32 v9, v10 offset:15616
  s_add_u32 m0, s76, 5280
  s_add_u32 s55, s54, 5120
  buffer_load_dwordx4 v22, s[32:35], s55 offen nt lds
  s_waitcnt vmcnt(21)
  s_add_u32 m0, s76, 6336
  s_add_u32 s55, s54, 6144
  buffer_load_dwordx4 v22, s[32:35], s55 offen nt lds
  s_waitcnt vmcnt(21)
  s_add_u32 m0, s76, 7392
  s_add_u32 s55, s54, 7168
  buffer_load_dwordx4 v22, s[32:35], s55 offen nt lds
  s_waitcnt vmcnt(21)
  s_add_u32 m0, s85, 8448
  s_add_u32 s55, s84, 0
  buffer_load_dwordx4 v22, s[36:39], s55 offen nt lds
  s_waitcnt vmcnt(21)
  s_add_u32 m0, s85, 9504
  s_add_u32 s55, s84, 1024
  buffer_load_dwordx4 v22, s[36:39], s55 offen nt lds
  s_waitcnt vmcnt(21)
  s_add_u32 m0, s85, 10560
  s_add_u32 s55, s84, 2048
  s_add_u32 s80, s76, 16896
  v_add_u32 v14, 4, v14
  v_add_u32 v13, 4, v13
  s_cmp_eq_u32 s80, 157696
  s_cselect_b32 s80, 22528, s80
  v_and_b32 v14, 15967, v14
  buffer_load_dwordx4 v22, s[36:39], s55 offen nt lds
  s_waitcnt vmcnt(21)
  s_add_u32 m0, s85, 11616
  s_add_u32 s55, s84, 3072
  buffer_load_dwordx4 v22, s[36:39], s55 offen nt lds
  s_waitcnt vmcnt(21)
  s_add_u32 m0, s85, 12672
  s_add_u32 s55, s84, 4096
  buffer_load_dwordx4 v22, s[36:39], s55 offen nt lds
  s_add_u32 s62, s79, -1
  s_max_i32 s81, s81, s62
  v_mov_b32 v10, s81
  s_waitcnt vmcnt(21)
  ds_write_b32 v9, v10 offset:15616
  s_add_u32 m0, s85, 13728
  s_add_u32 s55, s84, 5120
  buffer_load_dwordx4 v22, s[36:39], s55 offen nt lds
  s_waitcnt vmcnt(21)
  s_add_u32 m0, s85, 14784
  s_add_u32 s55, s84, 6144
  buffer_load_dwordx4 v22, s[36:39], s55 offen nt lds
  s_waitcnt vmcnt(21)
  s_add_u32 m0, s85, 15840
  s_add_u32 s55, s84, 7168
  buffer_load_dwordx4 v22, s[36:39], s55 offen nt lds
  ds_read_b32 v11, v14
  ds_read_b32 v12, v13
  ds_read_b32 v17, v18 offset:4
  s_waitcnt vmcnt(21)
  s_mov_b32 s84, s86
  s_mov_b32 s85, s89
  s_mov_b32 s86, s54
  s_mov_b32 s89, s76
  s_mov_b32 s76, s80
  s_add_u32 s77, s77, 1
  s_add_u32 s78, s78, 1
  s_cmp_eq_u32 s87, 0
  s_cbranch_scc1 L_ld
  s_branch L_lsp
L_ld_spin:
  s_cmp_eq_u32 s54, -2
  s_cbranch_scc1 L_ld_end
  ds_read_b32 v11, v14
  ds_read_b32 v12, v13
  s_sub_u32 s98, s98, 1
  s_cbranch_scc1 L_ld_end
  s_add_u32 s82, s82, 1
  s_cmp_lg_u32 s82, 1
  s_cbranch_scc1 L_ld_sp0
  s_add_u32 s62, s79, -3
  s_max_i32 s81, s81, s62
  v_mov_b32 v10, s81
  s_waitcnt vmcnt(24)
  ds_write_b32 v9, v10 offset:15616
  s_branch L_ld
L_ld_sp0:
  s_cmp_lg_u32 s82, 2
  s_cbranch_scc1 L_ld_sp1
  s_add_u32 s62, s79, -2
  s_max_i32 s81, s81, s62
  v_mov_b32 v10, s81
  s_waitcnt vmcnt(16)
  ds_write_b32 v9, v10 offset:15616
  s_branch L_ld
L_ld_sp1:
  s_cmp_lg_u32 s82, 3
  s_cbranch_scc1 L_ld_sp2
  s_add_u32 s62, s79, -1
  s_max_i32 s81, s81, s62
  v_mov_b32 v10, s81
  s_waitcnt vmcnt(8)
  ds_write_b32 v9, v10 offset:15616
  s_branch L_ld
L_ld_sp2:
  s_add_u32 s62, s79, 0
  s_max_i32 s81, s81, s62
  v_mov_b32 v10, s81
  s_waitcnt vmcnt(0)
  ds_write_b32 v9, v10 offset:15616
  s_branch L_ld
L_lsp:
  s_cmp_eq_u32 s87, 2
  s_cbranch_scc1 L_lsp2
  s_cmp_lg_u32 s87, 1
  s_cbranch_scc1 L_lsp1
  s_barrier
L_lsp1:
  s_load_dword s48, s[40:41], 0
  v_lshrrev_b32 v4, 4, v1
  v_and_b32 v5, 15, v1
  v_mov_b32 v15, 0xff
  s_mov_b32 s49, 0x05040100
  s_mov_b32 s50, 0x07060302
  s_mov_b32 s51, 0x3db504f3
  s_mov_b32 s52, 0x3fb8aa3b
  s_mov_b32 s97, 200000
  s_lshl_b32 s62, s59, 2
  s_add_u32 s62, s62, s58
  s_sub_u32 s62, s62, 20
  s_add_u32 s63, s58, 24
  s_cmp_eq_u32 s59, 12
  s_cselect_b32 s72, 4, 5
  s_cmp_ge_u32 s58, 4
  s_cselect_b32 s72, 2, s72
  s_cselect_b32 s60, s62, s63
  s_sub_u32 s62, s2, 64
  s_cmp_lt_u32 s59, 12
  s_cselect_b32 s72, 2, s72
  s_cselect_b32 s60, s62, s60
  s_sub_u32 s62, s59, 2
  s_cmp_lt_u32 s59, 10
  s_cselect_b32 s72, 1, s72
  s_cselect_b32 s60, s62, s60
  s_cmp_lt_u32 s59, 2
  s_cselect_b32 s72, 0, s72
  s_cselect_b32 s60, s2, s60
  s_sub_u32 s62, s59, 16
  s_cmp_ge_u32 s59, 16
  s_cselect_b32 s72, 3, s72
  s_cselect_b32 s60, s62, s60
  s_sub_u32 s62, s2, 192
  s_cmp_ge_u32 s59, 24
  s_cselect_b32 s72, 4, s72
  s_cselect_b32 s60, s62, s60
  s_cmp_ge_u32 s59, 27
  s_cselect_b32 s72, 5, s72
  s_sub_u32 s62, s72, 3
  s_cmp_lt_u32 s62, 2
  s_cselect_b32 s87, 2, 0
  s_mov_b32 s62, 4
  s_cmp_eq_u32 s72, 1
  s_cselect_b32 s62, 8, s62
  v_mov_b32 v10, s62
  ds_write_b32 v18, v10 offset:4
  s_branch L_ld
L_nl:
  v_lshrrev_b32 v4, 4, v1
  v_and_b32 v5, 15, v1
  v_mov_b32 v15, 0xff
  s_mov_b32 s49, 0x05040100
  s_mov_b32 s50, 0x07060302
  s_mov_b32 s51, 0x3db504f3
  s_mov_b32 s52, 0x3fb8aa3b
  s_mov_b32 s97, 200000
  s_lshl_b32 s62, s59, 2
  s_add_u32 s62, s62, s58
  s_sub_u32 s62, s62, 20
  s_add_u32 s63, s58, 24
  s_cmp_eq_u32 s59, 12
  s_cselect_b32 s72, 4, 5
  s_cmp_ge_u32 s58, 4
  s_cselect_b32 s72, 2, s72
  s_cselect_b32 s60, s62, s63
  s_sub_u32 s62, s2, 64
  s_cmp_lt_u32 s59, 12
  s_cselect_b32 s72, 2, s72
  s_cselect_b32 s60, s62, s60
  s_sub_u32 s62, s59, 2
  s_cmp_lt_u32 s59, 10
  s_cselect_b32 s72, 1, s72
  s_cselect_b32 s60, s62, s60
  s_cmp_lt_u32 s59, 2
  s_cselect_b32 s72, 0, s72
  s_cselect_b32 s60, s2, s60
  s_sub_u32 s62, s59, 16
  s_cmp_ge_u32 s59, 16
  s_cselect_b32 s72, 3, s72
  s_cselect_b32 s60, s62, s60
  s_sub_u32 s62, s2, 192
  s_cmp_ge_u32 s59, 24
  s_cselect_b32 s72, 4, s72
  s_cselect_b32 s60, s62, s60
  s_cmp_ge_u32 s59, 27
  s_cselect_b32 s72, 5, s72
  s_cmp_lt_u32 s3, 4
  s_cbranch_scc1 L_nu
  s_cmp_gt_u32 s72, 2
  s_cbranch_scc1 L_nu
  s_setprio 2
  s_and_b32 s89, s3, 3
  s_lshl_b32 s62, s58, 10
  s_cmp_eq_u32 s72, 1
  s_cselect_b32 s65, 4, 3
  s_cselect_b32 s62, s62, 0
  s_lshl_b32 s65, s65, 11
  s_lshl_b32 s66, s60, 7
  s_add_u32 s66, s66, s62
  s_lshl_b32 s46, s65, 9
  s_lshl_b32 s63, s89, 7
  s_mul_i32 s63, s63, s65
  s_add_u32 s63, s63, s66
  s_mul_i32 s64, s65, 57
  v_bfe_u32 v9, v1, 3, 1
  v_lshlrev_b32 v10, 5, v9
  v_lshl_add_u32 v9, v9, 2, v4
  v_lshlrev_b32 v9, 3, v9
  v_mul_u32_u24 v9, s65, v9
  v_and_b32 v11, 7, v1
  v_lshl_add_u32 v9, v11, 4, v9
  v_and_b32 v11, 1, v1
  v_lshl_add_u32 v10, v11, 4, v10
  v_lshl_add_u32 v10, v4, 2, v10
  v_bfe_u32 v11, v1, 1, 2
  v_add_u32 v10, v10, v11
  v_lshl_add_u32 v10, s89, 6, v10
  v_lshlrev_b32 v14, 2, v10
  s_waitcnt lgkmcnt(0)
  s_cmp_eq_u32 s72, 1
  s_cselect_b32 s44, s10, s24
  s_cselect_b32 s45, s11, s25
  s_cselect_b32 s56, s4, s22
  s_cselect_b32 s57, s5, s23
  s_load_dword s48, s[40:41], 0
  global_load_dword v20, v14, s[56:57]
  global_load_dwordx4 v[16:19], v3, s[4:5]
  buffer_load_dwordx4 v[192:195], v9, s[44:47], s63 offen nt
  s_add_u32 s63, s63, s65
  buffer_load_dwordx4 v[196:199], v9, s[44:47], s63 offen nt
  s_add_u32 s63, s63, s65
  buffer_load_dwordx4 v[200:203], v9, s[44:47], s63 offen nt
  s_add_u32 s63, s63, s65
  buffer_load_dwordx4 v[204:207], v9, s[44:47], s63 offen nt
  s_add_u32 s63, s63, s65
  buffer_load_dwordx4 v[208:211], v9, s[44:47], s63 offen nt
  s_add_u32 s63, s63, s65
  buffer_load_dwordx4 v[212:215], v9, s[44:47], s63 offen nt
  s_add_u32 s63, s63, s65
  buffer_load_dwordx4 v[216:219], v9, s[44:47], s63 offen nt
  s_add_u32 s63, s63, s65
  buffer_load_dwordx4 v[220:223], v9, s[44:47], s63 offen nt
  s_add_u32 s63, s63, s64
  buffer_load_dwordx4 v[224:227], v9, s[44:47], s63 offen nt
  s_add_u32 s63, s63, s65
  buffer_load_dwordx4 v[228:231], v9, s[44:47], s63 offen nt
  s_add_u32 s63, s63, s65
  buffer_load_dwordx4 v[232:235], v9, s[44:47], s63 offen nt
  s_add_u32 s63, s63, s65
  buffer_load_dwordx4 v[236:239], v9, s[44:47], s63 offen nt
  s_add_u32 s63, s63, s65
  buffer_load_dwordx4 v[240:243], v9, s[44:47], s63 offen nt
  s_add_u32 s63, s63, s65
  buffer_load_dwordx4 v[244:247], v9, s[44:47], s63 offen nt
  s_add_u32 s63, s63, s65
  buffer_load_dwordx4 v[248:251], v9, s[44:47], s63 offen nt
  s_add_u32 s63, s63, s65
  buffer_load_dwordx4 v[252:255], v9, s[44:47], s63 offen nt
  s_barrier
  s_waitcnt lgkmcnt(0)
  s_mul_i32 s67, s48, 1664525
  s_add_u32 s67, s67, 1013904223
  s_lshr_b32 s68, s67, 8
  s_lshr_b32 s69, s67, 16
  s_lshr_b32 s70, s67, 24
  s_waitcnt vmcnt(16)
  s_cmp_eq_u32 s72, 1
  s_cbranch_scc1 L_uq
  v_lshlrev_b32 v64, 16, v20
  v_and_b32 v65, 0xffff0000, v20
  v_mul_f32 v66, s52, v64
  v_mul_f32 v67, s52, v65
  v_exp_f32 v66, -v66
  v_exp_f32 v67, -v67
  v_add_f32 v66, 1.0, v66
  v_add_f32 v67, 1.0, v67
  v_rcp_f32 v66, v66
  v_rcp_f32 v67, v67
  v_mul_f32 v64, v64, v66
  v_mul_f32 v65, v65, v67
  v_cvt_pk_bf16_f32 v72, v64, v65
  s_nop 0
  s_branch L_ut
L_uq:
  v_lshlrev_b32 v64, 16, v16
  v_and_b32 v65, 0xffff0000, v16
  v_lshlrev_b32 v66, 16, v17
  v_and_b32 v67, 0xffff0000, v17
  v_lshlrev_b32 v68, 16, v18
  v_and_b32 v69, 0xffff0000, v18
  v_lshlrev_b32 v70, 16, v19
  v_and_b32 v71, 0xffff0000, v19
  v_add_f32 v72, v64, v65
  v_add_f32 v73, v66, v67
  v_add_f32 v74, v68, v69
  v_add_f32 v75, v70, v71
  v_add_f32 v72, v72, v73
  v_add_f32 v74, v74, v75
  v_add_f32 v80, v72, v74
  s_nop 1
  v_add_f32_dpp v80, v80, v80 row_ror:8 row_mask:0xf bank_mask:0xf
  s_nop 1
  v_add_f32_dpp v80, v80, v80 row_ror:4 row_mask:0xf bank_mask:0xf
  s_nop 1
  v_add_f32_dpp v80, v80, v80 row_ror:2 row_mask:0xf bank_mask:0xf
  s_nop 1
  v_add_f32_dpp v80, v80, v80 row_ror:1 row_mask:0xf bank_mask:0xf
  v_mov_b32 v72, v80
  s_nop 1
  v_permlane16_swap_b32 v80, v72
  v_add_f32 v80, v80, v72
  v_mov_b32 v72, v80
  s_nop 1
  v_permlane32_swap_b32 v80, v72
  v_add_f32 v80, v80, v72
  v_mul_f32 v80, 0x3b000000, v80
  v_sub_f32 v72, v64, v80
  v_sub_f32 v73, v65, v80
  v_sub_f32 v74, v66, v80
  v_sub_f32 v75, v67, v80
  v_sub_f32 v76, v68, v80
  v_sub_f32 v77, v69, v80
  v_sub_f32 v78, v70, v80
  v_sub_f32 v79, v71, v80
  v_mul_f32 v81, v72, v72
  v_fma_f32 v81, v73, v73, v81
  v_fma_f32 v81, v74, v74, v81
  v_fma_f32 v81, v75, v75, v81
  v_fma_f32 v81, v76, v76, v81
  v_fma_f32 v81, v77, v77, v81
  v_fma_f32 v81, v78, v78, v81
  v_fma_f32 v81, v79, v79, v81
  s_nop 1
  v_add_f32_dpp v81, v81, v81 row_ror:8 row_mask:0xf bank_mask:0xf
  s_nop 1
  v_add_f32_dpp v81, v81, v81 row_ror:4 row_mask:0xf bank_mask:0xf
  s_nop 1
  v_add_f32_dpp v81, v81, v81 row_ror:2 row_mask:0xf bank_mask:0xf
  s_nop 1
  v_add_f32_dpp v81, v81, v81 row_ror:1 row_mask:0xf bank_mask:0xf
  v_mov_b32 v72, v81
  s_nop 1
  v_permlane16_swap_b32 v81, v72
  v_add_f32 v81, v81, v72
  v_mov_b32 v72, v81
  s_nop 1
  v_permlane32_swap_b32 v81, v72
  v_add_f32 v81, v81, v72
  v_mul_f32 v81, 0x3b000000, v81
  v_lshlrev_b32 v64, 16, v20
  v_and_b32 v65, 0xffff0000, v20
  v_cvt_pk_bf16_f32 v80, 0, v80
  v_cvt_pk_bf16_f32 v81, 0, v81
  v_add_f32 v81, 0x3727c5ac, v81
  v_sub_f32 v64, v64, v80
  v_sub_f32 v65, v65, v80
  v_cvt_pk_bf16_f32 v81, 0, v81
  v_cvt_pk_bf16_f32 v64, 0, v64
  v_cvt_pk_bf16_f32 v65, 0, v65
  v_sqrt_f32 v81, v81
  s_nop 0
  v_cvt_pk_bf16_f32 v81, 0, v81
  v_rcp_f32 v80, v81
  s_nop 0
  v_mul_f32 v68, v64, v80
  v_mul_f32 v69, v65, v80
  v_fma_f32 v64, -v68, v81, v64
  v_fma_f32 v65, -v69, v81, v65
  v_fma_f32 v64, v64, v80, v68
  v_fma_f32 v65, v65, v80, v69
  v_cvt_pk_bf16_f32 v64, 0, v64
  v_cvt_pk_bf16_f32 v65, 0, v65
L_ut:
  v_mov_b32 v22, 15884
  v_mov_b32 v23, 1
  s_waitcnt vmcnt(8)
  v_perm_b32 v128, v196, v192, s49
  v_perm_b32 v129, v204, v200, s49
  v_perm_b32 v130, v212, v208, s49
  v_perm_b32 v131, v220, v216, s49
  v_perm_b32 v132, v196, v192, s50
  v_perm_b32 v133, v204, v200, s50
  v_perm_b32 v134, v212, v208, s50
  v_perm_b32 v135, v220, v216, s50
  v_perm_b32 v136, v197, v193, s49
  v_perm_b32 v137, v205, v201, s49
  v_perm_b32 v138, v213, v209, s49
  v_perm_b32 v139, v221, v217, s49
  v_perm_b32 v140, v197, v193, s50
  v_perm_b32 v141, v205, v201, s50
  v_perm_b32 v142, v213, v209, s50
  v_perm_b32 v143, v221, v217, s50
  v_perm_b32 v144, v198, v194, s49
  v_perm_b32 v145, v206, v202, s49
  v_perm_b32 v146, v214, v210, s49
  v_perm_b32 v147, v222, v218, s49
  v_perm_b32 v148, v198, v194, s50
  v_perm_b32 v149, v206, v202, s50
  v_perm_b32 v150, v214, v210, s50
  v_perm_b32 v151, v222, v218, s50
  v_perm_b32 v152, v199, v195, s49
  v_perm_b32 v153, v207, v203, s49
  v_perm_b32 v154, v215, v211, s49
  v_perm_b32 v155, v223, v219, s49
  v_perm_b32 v156, v199, v195, s50
  v_perm_b32 v157, v207, v203, s50
  v_perm_b32 v158, v215, v211, s50
  v_perm_b32 v159, v223, v219, s50
  s_waitcnt vmcnt(0)
  v_perm_b32 v160, v228, v224, s49
  v_perm_b32 v161, v236, v232, s49
  v_perm_b32 v162, v244, v240, s49
  v_perm_b32 v163, v252, v248, s49
  v_perm_b32 v164, v228, v224, s50
  v_perm_b32 v165, v236, v232, s50
  v_perm_b32 v166, v244, v240, s50
  v_perm_b32 v167, v252, v248, s50
  v_perm_b32 v168, v229, v225, s49
  v_perm_b32 v169, v237, v233, s49
  v_perm_b32 v170, v245, v241, s49
  v_perm_b32 v171, v253, v249, s49
  v_perm_b32 v172, v229, v225, s50
  v_perm_b32 v173, v237, v233, s50
  v_perm_b32 v174, v245, v241, s50
  v_perm_b32 v175, v253, v249, s50
  v_perm_b32 v176, v230, v226, s49
  v_perm_b32 v177, v238, v234, s49
  v_perm_b32 v178, v246, v242, s49
  v_perm_b32 v179, v254, v250, s49
  v_perm_b32 v180, v230, v226, s50
  v_perm_b32 v181, v238, v234, s50
  v_perm_b32 v182, v246, v242, s50
  v_perm_b32 v183, v254, v250, s50
  v_perm_b32 v184, v231, v227, s49
  v_perm_b32 v185, v239, v235, s49
  v_perm_b32 v186, v247, v243, s49
  v_perm_b32 v187, v255, v251, s49
  v_perm_b32 v188, v231, v227, s50
  v_perm_b32 v189, v239, v235, s50
  v_perm_b32 v190, v247, v243, s50
  v_perm_b32 v191, v255, v251, s50
  s_lshl_b32 s62, s66, 1
  s_and_b32 s63, s60, 0x38
  s_cmp_eq_u32 s63, 8
  s_cselect_b32 s64, 1.0, 0
  s_cmp_eq_u32 s63, 32
  s_cselect_b32 s64, 1.0, s64
  s_lshl_b32 s63, s89, 8
  s_add_u32 s63, s63, 16896
  v_lshlrev_b32 v9, 5, v1
  v_add_u32 v9, s63, v9
  s_cmp_eq_u32 s72, 1
  s_cselect_b32 s63, 24576, 0
  s_add_u32 s62, s62, s63
  s_add_u32 s62, s62, 8192
  s_add_u32 s63, s62, 1048576
  s_cmp_lg_u32 s72, 1
  s_cbranch_scc1 L_ua
  v_lshlrev_b32 v10, 3, v10
  s_mov_b32 s65, 1056768
  s_mov_b32 s61, s97
L_m_poll:
  buffer_load_dwordx2 v[96:97], v10, s[40:43], s65 offen sc1
  buffer_load_dwordx2 v[98:99], v10, s[40:43], s65 offen offset:2048 sc1
  s_waitcnt vmcnt(0)
  v_xor_b32 v11, s67, v97
  v_bitop3_b32 v11, v11, v99, s67 bitop3:0xf6
  v_cmp_ne_u32 vcc, 0, v11
  s_nop 0
  s_and_b64 exec, vcc, vcc
  s_nop 1
  s_cbranch_scc0 L_m_poll_ok
  s_sub_u32 s61, s61, 1
  s_cmp_lg_u32 s61, 0
  s_cbranch_scc1 L_m_poll
L_m_poll_ok:
  s_mov_b64 exec, -1
  v_lshlrev_b32 v100, 16, v98
  v_and_b32 v101, 0xffff0000, v98
  v_lshlrev_b32 v102, 16, v96
  v_and_b32 v103, 0xffff0000, v96
  v_mul_f32 v100, v100, v64
  v_mul_f32 v101, v101, v65
  v_cvt_pk_bf16_f32 v98, v100, v101
  v_lshlrev_b32 v100, 16, v98
  v_and_b32 v101, 0xffff0000, v98
  v_add_f32 v100, v100, v102
  v_add_f32 v101, v101, v103
  v_cvt_pk_bf16_f32 v72, v100, v101
L_ua:
  s_mov_b64 exec, 1
  ds_add_u32 v22, v23
  s_mov_b64 exec, -1
  v_mov_b32_dpp v73, v72 row_shl:2 row_mask:0xf bank_mask:0xf
  v_mov_b32_dpp v74, v72 row_shl:4 row_mask:0xf bank_mask:0xf
  v_mov_b32_dpp v75, v72 row_shl:6 row_mask:0xf bank_mask:0xf
  v_mov_b32_dpp v76, v72 row_shl:8 row_mask:0xf bank_mask:0xf
  v_mov_b32_dpp v77, v72 row_shl:10 row_mask:0xf bank_mask:0xf
  v_mov_b32_dpp v78, v72 row_shl:12 row_mask:0xf bank_mask:0xf
  v_mov_b32_dpp v79, v72 row_shl:14 row_mask:0xf bank_mask:0xf
  v_mfma_f32_16x16x32_bf16 v[32:35], v[72:75], v[128:131], 0
  v_mfma_f32_16x16x32_bf16 v[36:39], v[72:75], v[132:135], 0
  v_mfma_f32_16x16x32_bf16 v[40:43], v[72:75], v[136:139], 0
  v_mfma_f32_16x16x32_bf16 v[44:47], v[72:75], v[140:143], 0
  v_mfma_f32_16x16x32_bf16 v[48:51], v[72:75], v[144:147], 0
  v_mfma_f32_16x16x32_bf16 v[52:55], v[72:75], v[148:151], 0
  v_mfma_f32_16x16x32_bf16 v[56:59], v[72:75], v[152:155], 0
  v_mfma_f32_16x16x32_bf16 v[60:63], v[72:75], v[156:159], 0
  v_mfma_f32_16x16x32_bf16 v[32:35], v[76:79], v[160:163], v[32:35]
  v_mfma_f32_16x16x32_bf16 v[36:39], v[76:79], v[164:167], v[36:39]
  v_mfma_f32_16x16x32_bf16 v[40:43], v[76:79], v[168:171], v[40:43]
  v_mfma_f32_16x16x32_bf16 v[44:47], v[76:79], v[172:175], v[44:47]
  v_mfma_f32_16x16x32_bf16 v[48:51], v[76:79], v[176:179], v[48:51]
  v_mfma_f32_16x16x32_bf16 v[52:55], v[76:79], v[180:183], v[52:55]
  v_mfma_f32_16x16x32_bf16 v[56:59], v[76:79], v[184:187], v[56:59]
  v_mfma_f32_16x16x32_bf16 v[60:63], v[76:79], v[188:191], v[60:63]
  s_nop 0
  v_add_f32_dpp v64, v33, v32 row_ror:8 row_mask:0xf bank_mask:0xf
  v_add_f32_dpp v65, v37, v36 row_ror:8 row_mask:0xf bank_mask:0xf
  v_add_f32_dpp v66, v41, v40 row_ror:8 row_mask:0xf bank_mask:0xf
  v_add_f32_dpp v67, v45, v44 row_ror:8 row_mask:0xf bank_mask:0xf
  v_add_f32_dpp v68, v49, v48 row_ror:8 row_mask:0xf bank_mask:0xf
  v_add_f32_dpp v69, v53, v52 row_ror:8 row_mask:0xf bank_mask:0xf
  v_add_f32_dpp v70, v57, v56 row_ror:8 row_mask:0xf bank_mask:0xf
  v_add_f32_dpp v71, v61, v60 row_ror:8 row_mask:0xf bank_mask:0xf
  s_mov_b64 exec, 0xff
  ds_write_b128 v9, v[64:67]
  ds_write_b128 v9, v[68:71] offset:16
  v_mov_b32 v9, 15880
  s_mov_b64 exec, 1
  s_waitcnt lgkmcnt(0)
  ds_add_rtn_u32 v11, v9, v23
  s_mov_b64 exec, -1
  s_waitcnt lgkmcnt(0)
  v_readfirstlane_b32 s65, v11
  s_nop 0
  s_cmp_lg_u32 s65, 3
  s_nop 1
  s_cbranch_scc1 L_cons0
  s_mov_b64 exec, 0xffff
  ds_read_b128 v[32:35], v3 offset:16896
  ds_read_b128 v[36:39], v3 offset:17152
  ds_read_b128 v[40:43], v3 offset:17408
  ds_read_b128 v[44:47], v3 offset:17664
  v_mov_b32 v65, s67
  v_mov_b32 v67, s67
  s_waitcnt lgkmcnt(0)
  v_pk_add_f32 v[32:33], v[32:33], v[40:41]
  v_pk_add_f32 v[34:35], v[34:35], v[42:43]
  v_pk_add_f32 v[36:37], v[36:37], v[44:45]
  v_pk_add_f32 v[38:39], v[38:39], v[46:47]
  v_pk_add_f32 v[32:33], v[32:33], v[36:37]
  v_pk_add_f32 v[34:35], v[34:35], v[38:39]
  v_cvt_pk_bf16_f32 v64, v32, v33
  v_cvt_pk_bf16_f32 v66, v34, v35
  v_lshlrev_b32 v32, 16, v64
  v_and_b32 v33, 0xffff0000, v64
  v_lshlrev_b32 v34, 16, v66
  v_and_b32 v35, 0xffff0000, v66
  v_add_f32 v32, s64, v32
  v_add_f32 v33, s64, v33
  v_add_f32 v34, s64, v34
  v_add_f32 v35, s64, v35
  v_cvt_pk_bf16_f32 v64, v32, v33
  v_cvt_pk_bf16_f32 v66, v34, v35
  buffer_store_dwordx4 v[64:67], v3, s[40:43], s62 offen
  buffer_store_dwordx4 v[64:67], v3, s[40:43], s63 offen sc1
  s_mov_b64 exec, -1
  s_branch L_cons0
L_nu:
  s_waitcnt lgkmcnt(0)
  s_load_dword s48, s[40:41], 0
  s_barrier
  s_waitcnt lgkmcnt(0)
  s_mul_i32 s67, s48, 1664525
  s_add_u32 s67, s67, 1013904223
  s_lshr_b32 s68, s67, 8
  s_lshr_b32 s69, s67, 16
  s_lshr_b32 s70, s67, 24
  s_cmp_lg_u32 s3, 1
  s_cbranch_scc1 L_nx
  s_getreg_b32 s62, hwreg(HW_REG_XCC_ID)
  s_lshl_b32 s63, s58, 8
  s_lshl_b32 s64, s59, 3
  s_add_u32 s63, s63, s64
  s_add_u32 s63, s63, 4096
  v_mov_b32 v10, s62
  v_mov_b32 v11, s67
  v_mov_b32 v9, 0
  s_mov_b64 exec, 1
  buffer_store_dwordx2 v[10:11], v9, s[40:43], s63 offen sc1
  s_mov_b64 exec, -1
L_nx:
  s_cmp_lg_u32 s3, 2
  s_cbranch_scc1 L_cons0
  s_cmp_ge_u32 s58, 4
  s_cselect_b32 s62, 32, 0
  s_add_u32 s62, s62, s59
  s_mov_b32 s63, 0
  s_mov_b32 s64, 0
  s_cmp_ge_u32 s62, 0
  s_cselect_b32 s63, 64, s63
  s_cmp_ge_u32 s62, 2
  s_cselect_b32 s63, 62, s63
  s_cmp_ge_u32 s62, 10
  s_cselect_b32 s63, 320, s63
  s_cselect_b32 s64, 268435646, s64
  s_cmp_ge_u32 s62, 11
  s_cselect_b32 s64, 268435647, s64
  s_cmp_ge_u32 s62, 12
  s_cselect_b32 s63, 61, s63
  s_cselect_b32 s64, 0, s64
  s_cmp_ge_u32 s62, 13
  s_cselect_b32 s63, 16832, s63
  s_cselect_b32 s64, 539095869, s64
  s_cmp_ge_u32 s62, 14
  s_cselect_b32 s64, 807534141, s64
  s_cmp_ge_u32 s62, 15
  s_cselect_b32 s64, 805959230, s64
  s_cmp_ge_u32 s62, 16
  s_cselect_b32 s63, 62, s63
  s_cselect_b32 s64, 0, s64
  s_cmp_ge_u32 s62, 24
  s_cselect_b32 s63, 61, s63
  s_cmp_ge_u32 s62, 27
  s_cselect_b32 s63, 16832, s63
  s_cselect_b32 s64, 805961279, s64
  s_cmp_ge_u32 s62, 28
  s_cselect_b32 s63, 8768, s63
  s_cselect_b32 s64, 807793086, s64
  s_cmp_ge_u32 s62, 29
  s_cselect_b32 s63, 704, s63
  s_cselect_b32 s64, 268436734, s64
  s_cmp_ge_u32 s62, 30
  s_cselect_b32 s63, 8768, s63
  s_cselect_b32 s64, 807795135, s64
  s_cmp_ge_u32 s62, 31
  s_cselect_b32 s63, 704, s63
  s_cselect_b32 s64, 268436735, s64
  s_cmp_ge_u32 s62, 32
  s_cselect_b32 s63, 64, s63
  s_cselect_b32 s64, 0, s64
  s_cmp_ge_u32 s62, 34
  s_cselect_b32 s63, 62, s63
  s_cmp_ge_u32 s62, 42
  s_cselect_b32 s63, 320, s63
  s_cselect_b32 s64, 268435646, s64
  s_cmp_ge_u32 s62, 43
  s_cselect_b32 s64, 268435647, s64
  s_cmp_ge_u32 s62, 44
  s_cselect_b32 s64, 268436542, s64
  s_cmp_ge_u32 s62, 45
  s_cselect_b32 s64, 268436543, s64
  s_cmp_ge_u32 s62, 46
  s_cselect_b32 s64, 268435774, s64
  s_cmp_ge_u32 s62, 47
  s_cselect_b32 s64, 268435775, s64
  s_cmp_ge_u32 s62, 48
  s_cselect_b32 s63, 62, s63
  s_cselect_b32 s64, 0, s64
  s_cmp_ge_u32 s62, 56
  s_cselect_b32 s63, 61, s63
  s_cmp_ge_u32 s62, 59
  s_cselect_b32 s63, 832, s63
  s_cselect_b32 s64, 268436670, s64
  s_cmp_ge_u32 s62, 60
  s_cselect_b32 s64, 268436671, s64
  s_cmp_ge_u32 s62, 61
  s_cselect_b32 s63, 25024, s63
  s_cselect_b32 s64, 808580669, s64
  s_cmp_ge_u32 s62, 62
  s_cselect_b32 s64, 806221375, s64
  s_cmp_ge_u32 s62, 63
  s_cselect_b32 s63, 32960, s63
  s_cselect_b32 s64, 806222462, s64
  s_and_b32 s73, s63, 0x7f
  s_bfe_u32 s74, s63, 393223
  s_bfe_u32 s75, s63, 393229
  s_bfe_u32 s76, s64, 393238
  s_add_u32 s74, s74, s73
  s_add_u32 s75, s75, s74
  s_add_u32 s76, s76, s75
  s_lshl_b32 s77, s59, 6
  s_and_b32 s78, s64, 0x7ff
  s_bfe_u32 s79, s64, 720907
  s_lshr_b32 s80, s63, 19
  s_bitcmp1_b32 s64, 28
  s_cselect_b32 s81, 6, 0
  s_bitcmp1_b32 s64, 29
  s_cselect_b32 s82, 6, 0
  s_bitcmp1_b32 s64, 30
  s_cselect_b32 s83, 6, 0
  s_sub_u32 s62, s76, 3
  v_mov_b32 v9, 15888
  v_mov_b32 v10, s62
  ds_write_b32 v9, v10
  v_add_u32 v9, 40, v1
  v_add_u32 v10, s77, v9
  v_subrev_u32 v11, s73, v9
  v_lshlrev_b32 v11, s81, v11
  v_add_u32 v11, s78, v11
  v_cmp_le_u32 vcc, s73, v9
  s_nop 1
  v_cndmask_b32 v10, v10, v11, vcc
  v_subrev_u32 v11, s74, v9
  v_lshlrev_b32 v11, s82, v11
  v_add_u32 v11, s79, v11
  v_cmp_le_u32 vcc, s74, v9
  s_nop 1
  v_cndmask_b32 v10, v10, v11, vcc
  v_subrev_u32 v11, s75, v9
  v_lshlrev_b32 v11, s83, v11
  v_add_u32 v11, s80, v11
  v_cmp_le_u32 vcc, s75, v9
  s_nop 1
  v_cndmask_b32 v10, v10, v11, vcc
  v_lshlrev_b32 v10, 13, v10
  v_add_u32 v10, s53, v10
  v_cmp_gt_u32 vcc, s76, v9
  s_nop 1
  v_cndmask_b32 v10, -2, v10, vcc
  v_lshlrev_b32 v9, 2, v9
  ds_write_b32 v9, v10 offset:22016
  v_add_u32 v9, 104, v1
  v_add_u32 v10, s77, v9
  v_subrev_u32 v11, s73, v9
  v_lshlrev_b32 v11, s81, v11
  v_add_u32 v11, s78, v11
  v_cmp_le_u32 vcc, s73, v9
  s_nop 1
  v_cndmask_b32 v10, v10, v11, vcc
  v_subrev_u32 v11, s74, v9
  v_lshlrev_b32 v11, s82, v11
  v_add_u32 v11, s79, v11
  v_cmp_le_u32 vcc, s74, v9
  s_nop 1
  v_cndmask_b32 v10, v10, v11, vcc
  v_subrev_u32 v11, s75, v9
  v_lshlrev_b32 v11, s83, v11
  v_add_u32 v11, s80, v11
  v_cmp_le_u32 vcc, s75, v9
  s_nop 1
  v_cndmask_b32 v10, v10, v11, vcc
  v_lshlrev_b32 v10, 13, v10
  v_add_u32 v10, s53, v10
  v_cmp_gt_u32 vcc, s76, v9
  s_nop 1
  v_cndmask_b32 v10, -2, v10, vcc
  v_lshlrev_b32 v9, 2, v9
  s_mov_b64 exec, 16777215
  ds_write_b32 v9, v10 offset:22016
  s_mov_b64 exec, -1
  s_mov_b32 s62, 0
  s_cmp_eq_u32 s72, 3
  s_cselect_b32 s62, 6, s62
  s_lshl_b32 s76, s76, 1
  s_add_u32 s62, s62, s76
  v_mov_b32 v9, 15896
  v_mov_b32 v10, s62
  ds_write_b32 v9, v10
L_cons0:
  s_setprio 0
  v_and_b32 v9, 7, v1
  v_mul_u32_u24 v2, 1056, v9
  v_bfe_u32 v9, v1, 3, 1
  v_lshl_add_u32 v2, v9, 8, v2
  v_lshl_add_u32 v2, v4, 4, v2
  v_bfe_u32 v9, v1, 2, 3
  v_mul_u32_u24 v80, 1056, v9
  v_lshrrev_b32 v9, 5, v1
  v_lshl_add_u32 v80, v9, 8, v80
  v_and_b32 v9, 3, v1
  v_lshl_add_u32 v80, v9, 3, v80
  v_add_u32 v80, 8448, v80
  v_mov_b32 v14, 15872
  v_mov_b32 v83, 15616
  v_lshrrev_b32 v9, 2, v5
  v_lshlrev_b32 v84, 8, v9
  v_lshl_add_u32 v84, v4, 4, v84
  v_mov_b32 v85, 1
  v_mov_b32 v6, 0xff61b1e6
  v_mov_b32 v7, 0
  s_mov_b32 s88, 1
  s_mov_b32 s100, 2147483647
  s_mov_b32 s101, 0
  v_mov_b32 v32, 0
  v_mov_b32 v33, 0
  v_mov_b32 v34, 0
  v_mov_b32 v35, 0
  v_mov_b32 v36, 0
  v_mov_b32 v37, 0
  v_mov_b32 v38, 0
  v_mov_b32 v39, 0
  v_mov_b32 v40, 0
  v_mov_b32 v41, 0
  v_mov_b32 v42, 0
  v_mov_b32 v43, 0
  v_mov_b32 v44, 0
  v_mov_b32 v45, 0
  v_mov_b32 v46, 0
  v_mov_b32 v47, 0
  v_mov_b32 v48, 0
  v_mov_b32 v49, 0
  v_mov_b32 v50, 0
  v_mov_b32 v51, 0
  v_mov_b32 v52, 0
  v_mov_b32 v53, 0
  v_mov_b32 v54, 0
  v_mov_b32 v55, 0
  v_mov_b32 v56, 0
  v_mov_b32 v57, 0
  v_mov_b32 v58, 0
  v_mov_b32 v59, 0
  v_mov_b32 v60, 0
  v_mov_b32 v61, 0
  v_mov_b32 v62, 0
  v_mov_b32 v63, 0
  s_cmp_lt_u32 s2, 80
  s_cselect_b32 s30, 1, 3
  s_sub_u32 s62, s72, 3
  s_cmp_lt_u32 s62, 2
  s_cbranch_scc0 L_cst
L_ww:
  ds_read_b32 v10, v83
  s_sub_u32 s98, s98, 1
  s_cbranch_scc1 L_ww_to
  s_waitcnt lgkmcnt(0)
  v_readfirstlane_b32 s62, v10
  s_nop 0
  s_cmp_ge_i32 s62, 6
  s_nop 1
  s_cbranch_scc1 L_ww_ok
  s_sleep 1
  s_branch L_ww
L_ww_to:
  s_mov_b32 s98, 0
L_ww_ok:
L_wdyn:
  v_bfe_u32 v24, v1, 3, 1
  v_lshl_add_u32 v24, v24, 2, v4
  v_and_b32 v27, 7, v1
  v_lshlrev_b32 v27, 4, v27
  v_lshl_add_u32 v25, v24, 10, v27
  s_cmp_eq_u32 s72, 4
  s_cbranch_scc1 L_w1c_ffn
  s_mov_b32 s44, s12
  s_mov_b32 s45, s13
  s_mov_b32 s46, 4194304
  s_lshl_b32 s63, s58, 19
  s_lshl_b32 s64, s3, 15
  s_add_u32 s63, s63, s64
  s_lshr_b32 s64, s60, 2
  s_lshl_b32 s64, s64, 18
  s_add_u32 s63, s63, s64
  s_and_b32 s64, s60, 3
  s_lshl_b32 s64, s64, 8
  s_add_u32 s63, s63, s64
  s_mov_b32 s66, 4096
  v_lshlrev_b32 v25, 4, v5
  v_lshl_add_u32 v25, v4, 10, v25
  s_nop 0
  s_branch L_w1c_d
L_w1c_ffn:
  v_mul_u32_u24 v26, 3584, v24
  v_add_u32 v26, v26, v27
  s_mov_b32 s46, 1835008
  s_mul_i32 s65, s3, 229376
  s_lshl_b32 s64, s60, 7
  s_add_u32 s65, s65, s64
  s_mov_b32 s44, s16
  s_mov_b32 s45, s17
  s_mov_b32 s63, s65
  buffer_load_dwordx4 v[128:131], v26, s[44:47], s63 offen nt
  s_add_u32 s63, s63, 28672
  buffer_load_dwordx4 v[132:135], v26, s[44:47], s63 offen nt
  s_add_u32 s63, s63, 28672
  buffer_load_dwordx4 v[136:139], v26, s[44:47], s63 offen nt
  s_add_u32 s63, s63, 28672
  buffer_load_dwordx4 v[140:143], v26, s[44:47], s63 offen nt
  s_add_u32 s63, s63, 28672
  buffer_load_dwordx4 v[144:147], v26, s[44:47], s63 offen nt
  s_add_u32 s63, s63, 28672
  buffer_load_dwordx4 v[148:151], v26, s[44:47], s63 offen nt
  s_add_u32 s63, s63, 28672
  buffer_load_dwordx4 v[152:155], v26, s[44:47], s63 offen nt
  s_add_u32 s63, s63, 28672
  buffer_load_dwordx4 v[156:159], v26, s[44:47], s63 offen nt
  s_mov_b32 s44, s18
  s_mov_b32 s45, s19
  s_mov_b32 s63, s65
  buffer_load_dwordx4 v[160:163], v26, s[44:47], s63 offen nt
  s_add_u32 s63, s63, 28672
  buffer_load_dwordx4 v[164:167], v26, s[44:47], s63 offen nt
  s_add_u32 s63, s63, 28672
  buffer_load_dwordx4 v[168:171], v26, s[44:47], s63 offen nt
  s_add_u32 s63, s63, 28672
  buffer_load_dwordx4 v[172:175], v26, s[44:47], s63 offen nt
  s_add_u32 s63, s63, 28672
  buffer_load_dwordx4 v[176:179], v26, s[44:47], s63 offen nt
  s_add_u32 s63, s63, 28672
  buffer_load_dwordx4 v[180:183], v26, s[44:47], s63 offen nt
  s_add_u32 s63, s63, 28672
  buffer_load_dwordx4 v[184:187], v26, s[44:47], s63 offen nt
  s_add_u32 s63, s63, 28672
  buffer_load_dwordx4 v[188:191], v26, s[44:47], s63 offen nt
  s_mov_b32 s44, s20
  s_mov_b32 s45, s21
  s_lshl_b32 s63, s60, 16
  s_lshl_b32 s64, s3, 7
  s_add_u32 s63, s63, s64
  s_mov_b32 s66, 8192
L_w1c_d:
  buffer_load_dwordx4 v[192:195], v25, s[44:47], s63 offen nt
  s_add_u32 s63, s63, s66
  buffer_load_dwordx4 v[196:199], v25, s[44:47], s63 offen nt
  s_add_u32 s63, s63, s66
  buffer_load_dwordx4 v[200:203], v25, s[44:47], s63 offen nt
  s_add_u32 s63, s63, s66
  buffer_load_dwordx4 v[204:207], v25, s[44:47], s63 offen nt
  s_add_u32 s63, s63, s66
  buffer_load_dwordx4 v[208:211], v25, s[44:47], s63 offen nt
  s_add_u32 s63, s63, s66
  buffer_load_dwordx4 v[212:215], v25, s[44:47], s63 offen nt
  s_add_u32 s63, s63, s66
  buffer_load_dwordx4 v[216:219], v25, s[44:47], s63 offen nt
  s_add_u32 s63, s63, s66
  buffer_load_dwordx4 v[220:223], v25, s[44:47], s63 offen nt
L_w1c_e:
  s_waitcnt vmcnt(0)
L_w2:
  s_cmp_lg_u32 s72, 4
  s_cbranch_scc1 L_w2x
  v_mov_b32 v10, v130
  v_mov_b32 v11, v131
  v_mov_b32_dpp v130, v128 row_ror:8 row_mask:0xf bank_mask:0x3
  v_mov_b32_dpp v131, v129 row_ror:8 row_mask:0xf bank_mask:0x3
  v_mov_b32_dpp v128, v10 row_ror:8 row_mask:0xf bank_mask:0xc
  v_mov_b32_dpp v129, v11 row_ror:8 row_mask:0xf bank_mask:0xc
  v_mov_b32 v10, v134
  v_mov_b32 v11, v135
  v_mov_b32_dpp v134, v132 row_ror:8 row_mask:0xf bank_mask:0x3
  v_mov_b32_dpp v135, v133 row_ror:8 row_mask:0xf bank_mask:0x3
  v_mov_b32_dpp v132, v10 row_ror:8 row_mask:0xf bank_mask:0xc
  v_mov_b32_dpp v133, v11 row_ror:8 row_mask:0xf bank_mask:0xc
  v_mov_b32 v10, v138
  v_mov_b32 v11, v139
  v_mov_b32_dpp v138, v136 row_ror:8 row_mask:0xf bank_mask:0x3
  v_mov_b32_dpp v139, v137 row_ror:8 row_mask:0xf bank_mask:0x3
  v_mov_b32_dpp v136, v10 row_ror:8 row_mask:0xf bank_mask:0xc
  v_mov_b32_dpp v137, v11 row_ror:8 row_mask:0xf bank_mask:0xc
  v_mov_b32 v10, v142
  v_mov_b32 v11, v143
  v_mov_b32_dpp v142, v140 row_ror:8 row_mask:0xf bank_mask:0x3
  v_mov_b32_dpp v143, v141 row_ror:8 row_mask:0xf bank_mask:0x3
  v_mov_b32_dpp v140, v10 row_ror:8 row_mask:0xf bank_mask:0xc
  v_mov_b32_dpp v141, v11 row_ror:8 row_mask:0xf bank_mask:0xc
  v_mov_b32 v10, v146
  v_mov_b32 v11, v147
  v_mov_b32_dpp v146, v144 row_ror:8 row_mask:0xf bank_mask:0x3
  v_mov_b32_dpp v147, v145 row_ror:8 row_mask:0xf bank_mask:0x3
  v_mov_b32_dpp v144, v10 row_ror:8 row_mask:0xf bank_mask:0xc
  v_mov_b32_dpp v145, v11 row_ror:8 row_mask:0xf bank_mask:0xc
  v_mov_b32 v10, v150
  v_mov_b32 v11, v151
  v_mov_b32_dpp v150, v148 row_ror:8 row_mask:0xf bank_mask:0x3
  v_mov_b32_dpp v151, v149 row_ror:8 row_mask:0xf bank_mask:0x3
  v_mov_b32_dpp v148, v10 row_ror:8 row_mask:0xf bank_mask:0xc
  v_mov_b32_dpp v149, v11 row_ror:8 row_mask:0xf bank_mask:0xc
  v_mov_b32 v10, v154
  v_mov_b32 v11, v155
  v_mov_b32_dpp v154, v152 row_ror:8 row_mask:0xf bank_mask:0x3
  v_mov_b32_dpp v155, v153 row_ror:8 row_mask:0xf bank_mask:0x3
  v_mov_b32_dpp v152, v10 row_ror:8 row_mask:0xf bank_mask:0xc
  v_mov_b32_dpp v153, v11 row_ror:8 row_mask:0xf bank_mask:0xc
  v_mov_b32 v10, v158
  v_mov_b32 v11, v159
  v_mov_b32_dpp v158, v156 row_ror:8 row_mask:0xf bank_mask:0x3
  v_mov_b32_dpp v159, v157 row_ror:8 row_mask:0xf bank_mask:0x3
  v_mov_b32_dpp v156, v10 row_ror:8 row_mask:0xf bank_mask:0xc
  v_mov_b32_dpp v157, v11 row_ror:8 row_mask:0xf bank_mask:0xc
  v_mov_b32 v10, v162
  v_mov_b32 v11, v163
  v_mov_b32_dpp v162, v160 row_ror:8 row_mask:0xf bank_mask:0x3
  v_mov_b32_dpp v163, v161 row_ror:8 row_mask:0xf bank_mask:0x3
  v_mov_b32_dpp v160, v10 row_ror:8 row_mask:0xf bank_mask:0xc
  v_mov_b32_dpp v161, v11 row_ror:8 row_mask:0xf bank_mask:0xc
  v_mov_b32 v10, v166
  v_mov_b32 v11, v167
  v_mov_b32_dpp v166, v164 row_ror:8 row_mask:0xf bank_mask:0x3
  v_mov_b32_dpp v167, v165 row_ror:8 row_mask:0xf bank_mask:0x3
  v_mov_b32_dpp v164, v10 row_ror:8 row_mask:0xf bank_mask:0xc
  v_mov_b32_dpp v165, v11 row_ror:8 row_mask:0xf bank_mask:0xc
  v_mov_b32 v10, v170
  v_mov_b32 v11, v171
  v_mov_b32_dpp v170, v168 row_ror:8 row_mask:0xf bank_mask:0x3
  v_mov_b32_dpp v171, v169 row_ror:8 row_mask:0xf bank_mask:0x3
  v_mov_b32_dpp v168, v10 row_ror:8 row_mask:0xf bank_mask:0xc
  v_mov_b32_dpp v169, v11 row_ror:8 row_mask:0xf bank_mask:0xc
  v_mov_b32 v10, v174
  v_mov_b32 v11, v175
  v_mov_b32_dpp v174, v172 row_ror:8 row_mask:0xf bank_mask:0x3
  v_mov_b32_dpp v175, v173 row_ror:8 row_mask:0xf bank_mask:0x3
  v_mov_b32_dpp v172, v10 row_ror:8 row_mask:0xf bank_mask:0xc
  v_mov_b32_dpp v173, v11 row_ror:8 row_mask:0xf bank_mask:0xc
  v_mov_b32 v10, v178
  v_mov_b32 v11, v179
  v_mov_b32_dpp v178, v176 row_ror:8 row_mask:0xf bank_mask:0x3
  v_mov_b32_dpp v179, v177 row_ror:8 row_mask:0xf bank_mask:0x3
  v_mov_b32_dpp v176, v10 row_ror:8 row_mask:0xf bank_mask:0xc
  v_mov_b32_dpp v177, v11 row_ror:8 row_mask:0xf bank_mask:0xc
  v_mov_b32 v10, v182
  v_mov_b32 v11, v183
  v_mov_b32_dpp v182, v180 row_ror:8 row_mask:0xf bank_mask:0x3
  v_mov_b32_dpp v183, v181 row_ror:8 row_mask:0xf bank_mask:0x3
  v_mov_b32_dpp v180, v10 row_ror:8 row_mask:0xf bank_mask:0xc
  v_mov_b32_dpp v181, v11 row_ror:8 row_mask:0xf bank_mask:0xc
  v_mov_b32 v10, v186
  v_mov_b32 v11, v187
  v_mov_b32_dpp v186, v184 row_ror:8 row_mask:0xf bank_mask:0x3
  v_mov_b32_dpp v187, v185 row_ror:8 row_mask:0xf bank_mask:0x3
  v_mov_b32_dpp v184, v10 row_ror:8 row_mask:0xf bank_mask:0xc
  v_mov_b32_dpp v185, v11 row_ror:8 row_mask:0xf bank_mask:0xc
  v_mov_b32 v10, v190
  v_mov_b32 v11, v191
  v_mov_b32_dpp v190, v188 row_ror:8 row_mask:0xf bank_mask:0x3
  v_mov_b32_dpp v191, v189 row_ror:8 row_mask:0xf bank_mask:0x3
  v_mov_b32_dpp v188, v10 row_ror:8 row_mask:0xf bank_mask:0xc
  v_mov_b32_dpp v189, v11 row_ror:8 row_mask:0xf bank_mask:0xc
  v_mov_b32 v10, v194
  v_mov_b32 v11, v195
  v_mov_b32_dpp v194, v192 row_ror:8 row_mask:0xf bank_mask:0x3
  v_mov_b32_dpp v195, v193 row_ror:8 row_mask:0xf bank_mask:0x3
  v_mov_b32_dpp v192, v10 row_ror:8 row_mask:0xf bank_mask:0xc
  v_mov_b32_dpp v193, v11 row_ror:8 row_mask:0xf bank_mask:0xc
  v_mov_b32 v10, v198
  v_mov_b32 v11, v199
  v_mov_b32_dpp v198, v196 row_ror:8 row_mask:0xf bank_mask:0x3
  v_mov_b32_dpp v199, v197 row_ror:8 row_mask:0xf bank_mask:0x3
  v_mov_b32_dpp v196, v10 row_ror:8 row_mask:0xf bank_mask:0xc
  v_mov_b32_dpp v197, v11 row_ror:8 row_mask:0xf bank_mask:0xc
  v_mov_b32 v10, v202
  v_mov_b32 v11, v203
  v_mov_b32_dpp v202, v200 row_ror:8 row_mask:0xf bank_mask:0x3
  v_mov_b32_dpp v203, v201 row_ror:8 row_mask:0xf bank_mask:0x3
  v_mov_b32_dpp v200, v10 row_ror:8 row_mask:0xf bank_mask:0xc
  v_mov_b32_dpp v201, v11 row_ror:8 row_mask:0xf bank_mask:0xc
  v_mov_b32 v10, v206
  v_mov_b32 v11, v207
  v_mov_b32_dpp v206, v204 row_ror:8 row_mask:0xf bank_mask:0x3
  v_mov_b32_dpp v207, v205 row_ror:8 row_mask:0xf bank_mask:0x3
  v_mov_b32_dpp v204, v10 row_ror:8 row_mask:0xf bank_mask:0xc
  v_mov_b32_dpp v205, v11 row_ror:8 row_mask:0xf bank_mask:0xc
  v_mov_b32 v10, v210
  v_mov_b32 v11, v211
  v_mov_b32_dpp v210, v208 row_ror:8 row_mask:0xf bank_mask:0x3
  v_mov_b32_dpp v211, v209 row_ror:8 row_mask:0xf bank_mask:0x3
  v_mov_b32_dpp v208, v10 row_ror:8 row_mask:0xf bank_mask:0xc
  v_mov_b32_dpp v209, v11 row_ror:8 row_mask:0xf bank_mask:0xc
  v_mov_b32 v10, v214
  v_mov_b32 v11, v215
  v_mov_b32_dpp v214, v212 row_ror:8 row_mask:0xf bank_mask:0x3
  v_mov_b32_dpp v215, v213 row_ror:8 row_mask:0xf bank_mask:0x3
  v_mov_b32_dpp v212, v10 row_ror:8 row_mask:0xf bank_mask:0xc
  v_mov_b32_dpp v213, v11 row_ror:8 row_mask:0xf bank_mask:0xc
  v_mov_b32 v10, v218
  v_mov_b32 v11, v219
  v_mov_b32_dpp v218, v216 row_ror:8 row_mask:0xf bank_mask:0x3
  v_mov_b32_dpp v219, v217 row_ror:8 row_mask:0xf bank_mask:0x3
  v_mov_b32_dpp v216, v10 row_ror:8 row_mask:0xf bank_mask:0xc
  v_mov_b32_dpp v217, v11 row_ror:8 row_mask:0xf bank_mask:0xc
  v_mov_b32 v10, v222
  v_mov_b32 v11, v223
  v_mov_b32_dpp v222, v220 row_ror:8 row_mask:0xf bank_mask:0x3
  v_mov_b32_dpp v223, v221 row_ror:8 row_mask:0xf bank_mask:0x3
  v_mov_b32_dpp v220, v10 row_ror:8 row_mask:0xf bank_mask:0xc
  v_mov_b32_dpp v221, v11 row_ror:8 row_mask:0xf bank_mask:0xc
L_w2x:
  v_perm_b32 v224, v196, v192, s49
  v_perm_b32 v225, v204, v200, s49
  v_perm_b32 v226, v212, v208, s49
  v_perm_b32 v227, v220, v216, s49
  v_perm_b32 v228, v196, v192, s50
  v_perm_b32 v229, v204, v200, s50
  v_perm_b32 v230, v212, v208, s50
  v_perm_b32 v231, v220, v216, s50
  v_perm_b32 v232, v197, v193, s49
  v_perm_b32 v233, v205, v201, s49
  v_perm_b32 v234, v213, v209, s49
  v_perm_b32 v235, v221, v217, s49
  v_perm_b32 v236, v197, v193, s50
  v_perm_b32 v237, v205, v201, s50
  v_perm_b32 v238, v213, v209, s50
  v_perm_b32 v239, v221, v217, s50
  v_perm_b32 v240, v198, v194, s49
  v_perm_b32 v241, v206, v202, s49
  v_perm_b32 v242, v214, v210, s49
  v_perm_b32 v243, v222, v218, s49
  v_perm_b32 v244, v198, v194, s50
  v_perm_b32 v245, v206, v202, s50
  v_perm_b32 v246, v214, v210, s50
  v_perm_b32 v247, v222, v218, s50
  v_perm_b32 v248, v199, v195, s49
  v_perm_b32 v249, v207, v203, s49
  v_perm_b32 v250, v215, v211, s49
  v_perm_b32 v251, v223, v219, s49
  v_perm_b32 v252, v199, v195, s50
  v_perm_b32 v253, v207, v203, s50
  v_perm_b32 v254, v215, v211, s50
  v_perm_b32 v255, v223, v219, s50
  s_cmp_lg_u32 s72, 4
  s_cbranch_scc1 L_w2_d
L_w2_f:
  v_perm_b32 v192, v164, v160, s49
  v_perm_b32 v193, v172, v168, s49
  v_perm_b32 v194, v180, v176, s49
  v_perm_b32 v195, v188, v184, s49
  v_perm_b32 v196, v164, v160, s50
  v_perm_b32 v197, v172, v168, s50
  v_perm_b32 v198, v180, v176, s50
  v_perm_b32 v199, v188, v184, s50
  v_perm_b32 v200, v165, v161, s49
  v_perm_b32 v201, v173, v169, s49
  v_perm_b32 v202, v181, v177, s49
  v_perm_b32 v203, v189, v185, s49
  v_perm_b32 v204, v165, v161, s50
  v_perm_b32 v205, v173, v169, s50
  v_perm_b32 v206, v181, v177, s50
  v_perm_b32 v207, v189, v185, s50
  v_perm_b32 v208, v166, v162, s49
  v_perm_b32 v209, v174, v170, s49
  v_perm_b32 v210, v182, v178, s49
  v_perm_b32 v211, v190, v186, s49
  v_perm_b32 v212, v166, v162, s50
  v_perm_b32 v213, v174, v170, s50
  v_perm_b32 v214, v182, v178, s50
  v_perm_b32 v215, v190, v186, s50
  v_perm_b32 v216, v167, v163, s49
  v_perm_b32 v217, v175, v171, s49
  v_perm_b32 v218, v183, v179, s49
  v_perm_b32 v219, v191, v187, s49
  v_perm_b32 v220, v167, v163, s50
  v_perm_b32 v221, v175, v171, s50
  v_perm_b32 v222, v183, v179, s50
  v_perm_b32 v223, v191, v187, s50
  v_perm_b32 v160, v132, v128, s49
  v_perm_b32 v161, v140, v136, s49
  v_perm_b32 v162, v148, v144, s49
  v_perm_b32 v163, v156, v152, s49
  v_perm_b32 v164, v132, v128, s50
  v_perm_b32 v165, v140, v136, s50
  v_perm_b32 v166, v148, v144, s50
  v_perm_b32 v167, v156, v152, s50
  v_perm_b32 v168, v133, v129, s49
  v_perm_b32 v169, v141, v137, s49
  v_perm_b32 v170, v149, v145, s49
  v_perm_b32 v171, v157, v153, s49
  v_perm_b32 v172, v133, v129, s50
  v_perm_b32 v173, v141, v137, s50
  v_perm_b32 v174, v149, v145, s50
  v_perm_b32 v175, v157, v153, s50
  v_perm_b32 v176, v134, v130, s49
  v_perm_b32 v177, v142, v138, s49
  v_perm_b32 v178, v150, v146, s49
  v_perm_b32 v179, v158, v154, s49
  v_perm_b32 v180, v134, v130, s50
  v_perm_b32 v181, v142, v138, s50
  v_perm_b32 v182, v150, v146, s50
  v_perm_b32 v183, v158, v154, s50
  v_perm_b32 v184, v135, v131, s49
  v_perm_b32 v185, v143, v139, s49
  v_perm_b32 v186, v151, v147, s49
  v_perm_b32 v187, v159, v155, s49
  v_perm_b32 v188, v135, v131, s50
  v_perm_b32 v189, v143, v139, s50
  v_perm_b32 v190, v151, v147, s50
  v_perm_b32 v191, v159, v155, s50
L_w2_d:
  s_cmp_eq_u32 s3, 0
  s_cbranch_scc1 L_cbar
L_cst:
  s_lshl_b32 s79, s58, 7
  s_add_u32 s79, s79, 24576
  s_lshl_b32 s80, s59, 2
  s_add_u32 s80, s80, s79
  s_lshl_b32 s71, s67, 16
  s_cmp_ge_u32 s58, 4
  s_mov_b32 s84, 4294963184
  s_cselect_b32 s84, 4294963184, s84
  s_mov_b32 s85, 0xffff
  v_lshlrev_b32 v88, 2, v1
  v_mov_b32 v89, 1024
  v_cmp_gt_u32 vcc, 32, v1
  s_nop 1
  v_cndmask_b32 v88, v89, v88, vcc
  s_mov_b32 s99, 0x40880000
  s_cmp_eq_u32 s58, 1
  s_cselect_b32 s99, 0x4059999a, s99
  s_cmp_eq_u32 s58, 2
  s_cselect_b32 s99, 0x408ccccd, s99
  s_cmp_eq_u32 s58, 3
  s_cselect_b32 s99, 0x407ae148, s99
  s_cmp_eq_u32 s58, 4
  s_cselect_b32 s99, 0x40a4cccd, s99
  s_cmp_eq_u32 s58, 5
  s_cselect_b32 s99, 0x40880000, s99
  s_cmp_eq_u32 s58, 6
  s_cselect_b32 s99, 0x40980000, s99
  s_cmp_eq_u32 s58, 7
  s_cselect_b32 s99, 0x40866666, s99
  s_branch L_tk
L_next:
  s_cmp_gt_u32 s73, s29
  s_cbranch_scc1 L_tk
  s_sub_u32 s62, s96, s86
  s_max_i32 s63, s62, 12
  s_min_i32 s63, s63, 24
  s_lshl_b32 s62, s62, 5
  s_add_u32 s62, s62, s84
  v_cvt_f32_u32 v10, s63
  s_waitcnt vmcnt(0)
  v_xor_b32 v89, s71, v89
  v_cmp_lt_u32 vcc, s85, v89
  s_nop 0
  v_add_u32_dpp v11, v89, v89 row_ror:8 row_mask:0xf bank_mask:0xf
  v_rcp_f32 v10, v10
  s_nop 0
  v_add_u32_dpp v11, v11, v11 row_ror:4 row_mask:0xf bank_mask:0xf
  s_nop 1
  v_add_u32_dpp v11, v11, v11 row_ror:2 row_mask:0xf bank_mask:0xf
  s_nop 1
  v_add_u32_dpp v11, v11, v11 row_ror:1 row_mask:0xf bank_mask:0xf
  v_mul_f32 v10, 0x3fa00000, v10
  v_mov_b32 v89, v11
  s_cmp_lg_u32 vcc_lo, 0
  s_nop 0
  v_permlane16_swap_b32 v89, v11
  v_add3_u32 v89, v89, v11, s62
  v_cvt_f32_i32 v89, v89
  v_fma_f32 v10, v89, v10, s99
  v_cvt_flr_i32_f32 v11, v10
  v_med3_i32 v11, v11, 0, 10
  s_nop 0
  s_cbranch_scc1 L_tk
  s_mov_b64 exec, 1
  ds_write_b32 v83, v11 offset:276
L_tk:
L_tk0:
  s_mov_b64 exec, 1
  ds_add_rtn_u32 v13, v14, v85
  s_mov_b64 exec, -1
  s_waitcnt lgkmcnt(0)
  v_readfirstlane_b32 s73, v13
  s_nop 0
  s_and_b32 s62, s73, 7
  s_mul_i32 s63, s62, 16896
  s_add_u32 s63, s63, 22528
  s_lshl_b32 s62, s62, 2
  s_add_u32 s62, s62, 15936
  s_lshl_b32 s74, s73, 1
  s_add_u32 s75, s74, 4
  s_sub_u32 s74, s74, 1
  s_add_u32 s73, s73, 1
  s_max_i32 s74, s74, s73
  v_add_u32 v81, s63, v2
  v_add_u32 v82, s63, v80
  v_mov_b32 v86, s62
  v_mov_b32 v87, s73
  s_cmp_ge_u32 s73, s100
  s_cbranch_scc1 L_eg
L_kw:
  ds_read2_b32 v[10:11], v83 offset0:0 offset1:68
  s_sub_u32 s98, s98, 1
  s_cbranch_scc1 L_kw_to
  s_waitcnt lgkmcnt(0)
  v_readfirstlane_b32 s62, v10
  s_nop 0
  s_cmp_ge_i32 s62, s74
  s_nop 1
  s_cbranch_scc1 L_kw_ok
  v_readfirstlane_b32 s100, v11
  s_nop 0
  s_cmp_ge_u32 s73, s100
  s_nop 1
  s_cbranch_scc1 L_eg
  s_sleep 1
  s_branch L_kw
L_kw_to:
  s_mov_b32 s98, 0
  s_branch L_done
L_kw_ok:
  v_readfirstlane_b32 s100, v11
  s_nop 0
  s_cmp_ge_u32 s73, s100
  s_nop 1
  s_cbranch_scc1 L_eg
  s_mov_b32 s86, s62
  s_or_b32 s62, s62, s71
  v_mov_b32 v89, s62
  s_mov_b64 exec, 1
  buffer_store_dword v89, v88, s[40:43], s80 offen
  s_mov_b64 exec, -1
  buffer_load_dword v89, v88, s[40:43], s79 offen sc1
  ds_read_b128 v[96:99], v81 offset:0
  ds_read_b128 v[112:115], v81 offset:512
  ds_read_b128 v[100:103], v81 offset:64
  ds_read_b128 v[116:119], v81 offset:576
  ds_read_b128 v[104:107], v81 offset:128
  ds_read_b128 v[120:123], v81 offset:640
  ds_read_b128 v[108:111], v81 offset:192
  ds_read_b128 v[124:127], v81 offset:704
  s_cmp_eq_u32 s88, 0
  s_cbranch_scc1 L_qk
L_vw0:
  ds_read_b32 v10, v83
  s_sub_u32 s98, s98, 1
  s_cbranch_scc1 L_vw0_to
  s_waitcnt lgkmcnt(0)
  v_readfirstlane_b32 s62, v10
  s_nop 0
  s_cmp_ge_i32 s62, s75
  s_nop 1
  s_cbranch_scc1 L_vw0_ok
  s_sleep 1
  s_branch L_vw0
L_vw0_to:
  s_mov_b32 s98, 0
L_vw0_ok:
  ds_read_b64_tr_b16 v[128:129], v82 offset:0
  ds_read_b64_tr_b16 v[130:131], v82 offset:512
  ds_read_b64_tr_b16 v[132:133], v82 offset:32
  ds_read_b64_tr_b16 v[134:135], v82 offset:544
  ds_read_b64_tr_b16 v[136:137], v82 offset:64
  ds_read_b64_tr_b16 v[138:139], v82 offset:576
  ds_read_b64_tr_b16 v[140:141], v82 offset:96
  ds_read_b64_tr_b16 v[142:143], v82 offset:608
  ds_read_b64_tr_b16 v[144:145], v82 offset:128
  ds_read_b64_tr_b16 v[146:147], v82 offset:640
  ds_read_b64_tr_b16 v[148:149], v82 offset:160
  ds_read_b64_tr_b16 v[150:151], v82 offset:672
  ds_read_b64_tr_b16 v[152:153], v82 offset:192
  ds_read_b64_tr_b16 v[154:155], v82 offset:704
  ds_read_b64_tr_b16 v[156:157], v82 offset:224
  ds_read_b64_tr_b16 v[158:159], v82 offset:736
  s_waitcnt lgkmcnt(0)
  s_mov_b64 exec, 1
  ds_write_b32 v86, v87
  s_mov_b64 exec, -1
  s_cmp_lg_u32 s73, s30
  s_cbranch_scc1 L_fl0
L_qp0:
  s_setprio 2
  s_lshl_b32 s62, s58, 11
  s_add_u32 s62, s62, 32768
  s_add_u32 s63, s62, 1048576
  s_mov_b32 s61, s97
L_qp:
  buffer_load_dwordx4 v[64:67], v3, s[40:43], s62 offen offset:0 sc1
  buffer_load_dwordx4 v[68:71], v3, s[40:43], s62 offen offset:1024 sc1
  s_waitcnt vmcnt(0)
  v_xor_b32 v11, s67, v65
  v_bitop3_b32 v11, v11, v67, s67 bitop3:0xf6
  v_bitop3_b32 v11, v11, v69, s67 bitop3:0xf6
  v_bitop3_b32 v11, v11, v71, s67 bitop3:0xf6
  v_cmp_ne_u32 vcc, 0, v11
  s_nop 4
  s_cbranch_vccz L_qp_ok
  s_sub_u32 s61, s61, 1
  s_cmp_lt_u32 s61, 199960
  s_cselect_b32 s63, 1048576, 0
  s_xor_b32 s62, s62, s63
  s_cmp_lg_u32 s61, 0
  s_cbranch_scc1 L_qp
L_qp_ok:
  s_mov_b64 vcc, 0
  v_cndmask_b32 v64, v64, v72, vcc
  v_cndmask_b32 v65, v66, v74, vcc
  v_cndmask_b32 v66, v68, v76, vcc
  v_cndmask_b32 v67, v70, v78, vcc
  v_lshlrev_b32 v9, 3, v1
  ds_write_b64 v9, v[64:65] offset:14592
  ds_write_b64 v9, v[66:67] offset:15104
  v_mov_b32 v9, 15876
  ds_write_b32 v9, v85
  s_setprio 0
L_fl0:
  v_mov_b32 v9, 15876
L_fl:
  ds_read_b32 v10, v9
  s_sub_u32 s98, s98, 1
  s_cbranch_scc1 L_fl_to
  s_waitcnt lgkmcnt(0)
  v_readfirstlane_b32 s62, v10
  s_nop 0
  s_cmp_lg_u32 s62, 0
  s_nop 1
  s_cbranch_scc1 L_fl_ok
  s_sleep 1
  s_branch L_fl
L_fl_to:
  s_mov_b32 s98, 0
L_fl_ok:
  s_lshl_b32 s62, s58, 8
  s_add_u32 s62, s62, 4096
  v_and_b32 v92, 31, v1
  v_lshlrev_b32 v92, 3, v92
  buffer_load_dwordx2 v[90:91], v92, s[40:43], s62 offen sc1
  ds_read_b128 v[16:19], v84 offset:14592
  ds_read_b128 v[20:23], v84 offset:14656
  ds_read_b128 v[24:27], v84 offset:14720
  ds_read_b128 v[28:31], v84 offset:14784
  ds_read_b32 v10, v83 offset:280
  s_waitcnt lgkmcnt(0)
  v_readfirstlane_b32 s29, v10
  s_nop 0
  s_mov_b32 s96, s29
  s_lshr_b32 s29, s29, 1
  s_sub_u32 s29, s29, 6
L_qk:
  s_waitcnt lgkmcnt(6)
  v_mfma_f32_16x16x32_bf16 v[64:67], v[96:99], v[16:19], 0
  v_mfma_f32_16x16x32_bf16 v[68:71], v[112:115], v[16:19], 0
  s_waitcnt lgkmcnt(4)
  v_mfma_f32_16x16x32_bf16 v[64:67], v[100:103], v[20:23], v[64:67]
  v_mfma_f32_16x16x32_bf16 v[68:71], v[116:119], v[20:23], v[68:71]
  s_waitcnt lgkmcnt(2)
  v_mfma_f32_16x16x32_bf16 v[64:67], v[104:107], v[24:27], v[64:67]
  v_mfma_f32_16x16x32_bf16 v[68:71], v[120:123], v[24:27], v[68:71]
  s_waitcnt lgkmcnt(0)
  v_mfma_f32_16x16x32_bf16 v[64:67], v[108:111], v[28:31], v[64:67]
  v_mfma_f32_16x16x32_bf16 v[68:71], v[124:127], v[28:31], v[68:71]
  s_nop 6
  v_cvt_pk_bf16_f32 v64, 0, v64
  v_cvt_pk_bf16_f32 v65, 0, v65
  v_cvt_pk_bf16_f32 v66, 0, v66
  v_cvt_pk_bf16_f32 v67, 0, v67
  v_cvt_pk_bf16_f32 v68, 0, v68
  v_cvt_pk_bf16_f32 v69, 0, v69
  v_cvt_pk_bf16_f32 v70, 0, v70
  v_cvt_pk_bf16_f32 v71, 0, v71
  v_mul_f32 v64, s51, v64
  v_mul_f32 v65, s51, v65
  v_mul_f32 v66, s51, v66
  v_mul_f32 v67, s51, v67
  v_mul_f32 v68, s51, v68
  v_mul_f32 v69, s51, v69
  v_mul_f32 v70, s51, v70
  v_mul_f32 v71, s51, v71
  v_cvt_pk_bf16_f32 v64, 0, v64
  v_cvt_pk_bf16_f32 v65, 0, v65
  v_cvt_pk_bf16_f32 v66, 0, v66
  v_cvt_pk_bf16_f32 v67, 0, v67
  v_cvt_pk_bf16_f32 v68, 0, v68
  v_cvt_pk_bf16_f32 v69, 0, v69
  v_cvt_pk_bf16_f32 v70, 0, v70
  v_cvt_pk_bf16_f32 v71, 0, v71
  v_max3_f32 v9, v64, v65, v66
  v_max3_f32 v10, v67, v68, v69
  v_max3_f32 v9, v9, v70, v71
  v_max_f32 v9, v9, v10
  v_cmp_gt_f32 vcc, v9, v6
  s_nop 4
  s_cbranch_vccz L_nors
  v_max_f32 v9, v9, v6
  v_mov_b32 v10, v9
  s_nop 1
  v_permlane16_swap_b32 v9, v10
  v_max_f32 v9, v9, v10
  v_mov_b32 v10, v9
  s_nop 1
  v_permlane32_swap_b32 v9, v10
  v_max_f32 v9, v9, v10
  v_sub_f32 v8, v6, v9
  v_mul_f32 v8, s52, v8
  v_exp_f32 v8, v8
  v_mov_b32 v6, v9
  v_mul_f32 v7, v7, v8
  v_mul_f32 v32, v8, v32
  v_mul_f32 v33, v8, v33
  v_mul_f32 v34, v8, v34
  v_mul_f32 v35, v8, v35
  v_mul_f32 v36, v8, v36
  v_mul_f32 v37, v8, v37
  v_mul_f32 v38, v8, v38
  v_mul_f32 v39, v8, v39
  v_mul_f32 v40, v8, v40
  v_mul_f32 v41, v8, v41
  v_mul_f32 v42, v8, v42
  v_mul_f32 v43, v8, v43
  v_mul_f32 v44, v8, v44
  v_mul_f32 v45, v8, v45
  v_mul_f32 v46, v8, v46
  v_mul_f32 v47, v8, v47
  v_mul_f32 v48, v8, v48
  v_mul_f32 v49, v8, v49
  v_mul_f32 v50, v8, v50
  v_mul_f32 v51, v8, v51
  v_mul_f32 v52, v8, v52
  v_mul_f32 v53, v8, v53
  v_mul_f32 v54, v8, v54
  v_mul_f32 v55, v8, v55
  v_mul_f32 v56, v8, v56
  v_mul_f32 v57, v8, v57
  v_mul_f32 v58, v8, v58
  v_mul_f32 v59, v8, v59
  v_mul_f32 v60, v8, v60
  v_mul_f32 v61, v8, v61
  v_mul_f32 v62, v8, v62
  v_mul_f32 v63, v8, v63
L_nors:
  v_sub_f32 v64, v64, v6
  v_sub_f32 v65, v65, v6
  v_sub_f32 v66, v66, v6
  v_sub_f32 v67, v67, v6
  v_sub_f32 v68, v68, v6
  v_sub_f32 v69, v69, v6
  v_sub_f32 v70, v70, v6
  v_sub_f32 v71, v71, v6
  v_mul_f32 v64, s52, v64
  v_mul_f32 v65, s52, v65
  v_mul_f32 v66, s52, v66
  v_mul_f32 v67, s52, v67
  v_mul_f32 v68, s52, v68
  v_mul_f32 v69, s52, v69
  v_mul_f32 v70, s52, v70
  v_mul_f32 v71, s52, v71
  v_exp_f32 v64, v64
  v_exp_f32 v65, v65
  v_exp_f32 v66, v66
  v_exp_f32 v67, v67
  v_exp_f32 v68, v68
  v_exp_f32 v69, v69
  v_exp_f32 v70, v70
  v_exp_f32 v71, v71
  v_cvt_pk_bf16_f32 v72, v64, v65
  v_cvt_pk_bf16_f32 v73, v66, v67
  v_cvt_pk_bf16_f32 v74, v68, v69
  v_cvt_pk_bf16_f32 v75, v70, v71
  v_add_f32 v76, v64, v65
  v_add_f32 v77, v66, v67
  v_add_f32 v78, v68, v69
  v_add_f32 v79, v70, v71
  v_add_f32 v76, v76, v77
  v_add_f32 v78, v78, v79
  v_add_f32 v76, v76, v78
  v_add_f32 v7, v7, v76
  s_cmp_lg_u32 s101, 0
  s_cbranch_scc1 L_hp
  s_cmp_lg_u32 s88, 0
  s_cbranch_scc1 L_pv0
L_vw:
  ds_read_b32 v10, v83
  s_sub_u32 s98, s98, 1
  s_cbranch_scc1 L_vw_to
  s_waitcnt lgkmcnt(0)
  v_readfirstlane_b32 s62, v10
  s_nop 0
  s_cmp_ge_i32 s62, s75
  s_nop 1
  s_cbranch_scc1 L_vw_ok
  s_sleep 1
  s_branch L_vw
L_vw_to:
  s_mov_b32 s98, 0
L_vw_ok:
  ds_read_b64_tr_b16 v[128:129], v82 offset:0
  ds_read_b64_tr_b16 v[130:131], v82 offset:512
  ds_read_b64_tr_b16 v[132:133], v82 offset:32
  ds_read_b64_tr_b16 v[134:135], v82 offset:544
  ds_read_b64_tr_b16 v[136:137], v82 offset:64
  ds_read_b64_tr_b16 v[138:139], v82 offset:576
  ds_read_b64_tr_b16 v[140:141], v82 offset:96
  ds_read_b64_tr_b16 v[142:143], v82 offset:608
  ds_read_b64_tr_b16 v[144:145], v82 offset:128
  ds_read_b64_tr_b16 v[146:147], v82 offset:640
  ds_read_b64_tr_b16 v[148:149], v82 offset:160
  ds_read_b64_tr_b16 v[150:151], v82 offset:672
  ds_read_b64_tr_b16 v[152:153], v82 offset:192
  ds_read_b64_tr_b16 v[154:155], v82 offset:704
  ds_read_b64_tr_b16 v[156:157], v82 offset:224
  ds_read_b64_tr_b16 v[158:159], v82 offset:736
  s_waitcnt lgkmcnt(14)
  v_mfma_f32_16x16x32_bf16 v[32:35], v[128:131], v[72:75], v[32:35]
  s_waitcnt lgkmcnt(12)
  v_mfma_f32_16x16x32_bf16 v[36:39], v[132:135], v[72:75], v[36:39]
  s_waitcnt lgkmcnt(10)
  v_mfma_f32_16x16x32_bf16 v[40:43], v[136:139], v[72:75], v[40:43]
  s_waitcnt lgkmcnt(8)
  v_mfma_f32_16x16x32_bf16 v[44:47], v[140:143], v[72:75], v[44:47]
  s_waitcnt lgkmcnt(6)
  v_mfma_f32_16x16x32_bf16 v[48:51], v[144:147], v[72:75], v[48:51]
  s_waitcnt lgkmcnt(4)
  v_mfma_f32_16x16x32_bf16 v[52:55], v[148:151], v[72:75], v[52:55]
  s_waitcnt lgkmcnt(2)
  v_mfma_f32_16x16x32_bf16 v[56:59], v[152:155], v[72:75], v[56:59]
  s_waitcnt lgkmcnt(0)
  s_mov_b64 exec, 1
  ds_write_b32 v86, v87
  s_mov_b64 exec, -1
  v_mfma_f32_16x16x32_bf16 v[60:63], v[156:159], v[72:75], v[60:63]
  s_nop 6
  s_branch L_next
L_pv0:
  s_sub_u32 s88, s88, 1
  v_mfma_f32_16x16x32_bf16 v[32:35], v[128:131], v[72:75], v[32:35]
  v_mfma_f32_16x16x32_bf16 v[36:39], v[132:135], v[72:75], v[36:39]
  v_mfma_f32_16x16x32_bf16 v[40:43], v[136:139], v[72:75], v[40:43]
  v_mfma_f32_16x16x32_bf16 v[44:47], v[140:143], v[72:75], v[44:47]
  v_mfma_f32_16x16x32_bf16 v[48:51], v[144:147], v[72:75], v[48:51]
  v_mfma_f32_16x16x32_bf16 v[52:55], v[148:151], v[72:75], v[52:55]
  v_mfma_f32_16x16x32_bf16 v[56:59], v[152:155], v[72:75], v[56:59]
  v_mfma_f32_16x16x32_bf16 v[60:63], v[156:159], v[72:75], v[60:63]
  s_getreg_b32 s62, hwreg(HW_REG_XCC_ID)
  s_waitcnt vmcnt(0)
  v_cmp_ne_u32 vcc, s62, v90
  v_cmp_ne_u32 s[62:63], s67, v91
  s_nop 1
  s_or_b64 s[62:63], s[62:63], vcc
  s_cselect_b32 s94, 1, 0
  s_sub_u32 s62, s72, 3
  s_cmp_ge_u32 s62, 2
  s_nop 4
  s_cbranch_scc1 L_next
L_prep:
  s_cmp_eq_u32 s72, 4
  s_cbranch_scc1 L_prep_f
  s_lshl_b32 s62, s58, 8
  s_add_u32 s62, s62, 4096
  v_and_b32 v9, 31, v1
  v_lshlrev_b32 v9, 3, v9
  s_lshl_b32 s63, s58, 2
  s_add_u32 s63, s63, s60
  s_lshl_b32 s63, s63, 4
  v_and_b32 v10, 3, v1
  v_lshl_add_u32 v10, v10, 2, v4
  v_add_u32 v10, s63, v10
  v_and_b32 v10, 511, v10
  s_mov_b32 s64, 1067008
  s_branch L_prep_c
L_prep_f:
  s_lshl_b32 s62, s3, 6
  v_lshl_add_u32 v10, v5, 2, v4
  v_add_u32 v10, s62, v10
  v_lshrrev_b32 v9, 1, v10
  v_lshlrev_b32 v9, 3, v9
  s_mov_b32 s62, 1062912
  s_mov_b32 s64, 1064960
L_prep_c:
  v_lshlrev_b32 v94, 1, v10
  v_mov_b32 v90, 0
  global_load_short_d16_hi v90, v94, s[4:5]
  v_and_b32 v8, 1, v10
  v_lshlrev_b32 v8, 4, v8
  v_sub_u32 v8, 16, v8
  v_lshrrev_b32 v10, 1, v10
  v_lshlrev_b32 v10, 3, v10
  s_mov_b32 s63, 1060864
  s_mov_b32 s61, s97
L_x_poll:
  buffer_load_dwordx2 v[96:97], v9, s[40:43], s62 offen sc1
  buffer_load_dwordx2 v[98:99], v10, s[40:43], s63 offen sc1
  buffer_load_dwordx2 v[100:101], v10, s[40:43], s64 offen sc1
  s_waitcnt vmcnt(0)
  v_xor_b32 v11, s67, v97
  v_bitop3_b32 v11, v11, v99, s67 bitop3:0xf6
  v_bitop3_b32 v11, v11, v101, s67 bitop3:0xf6
  v_cmp_ne_u32 vcc, 0, v11
  s_nop 0
  s_and_b64 exec, vcc, vcc
  s_nop 1
  s_cbranch_scc0 L_x_poll_ok
  s_sub_u32 s61, s61, 1
  s_cmp_lg_u32 s61, 0
  s_cbranch_scc1 L_x_poll
L_x_poll_ok:
  s_mov_b64 exec, -1
  v_lshlrev_b32 v91, v8, v98
  v_and_b32 v91, 0xffff0000, v91
  v_lshlrev_b32 v92, v8, v100
  v_and_b32 v92, 0xffff0000, v92
  v_lshlrev_b32 v93, v8, v96
  v_and_b32 v93, 0xffff0000, v93
  s_getreg_b32 s62, hwreg(HW_REG_XCC_ID)
  v_cmp_ne_u32 vcc, s62, v96
  s_lshl_b32 s31, s58, 2
  s_add_u32 s31, s31, s60
  s_lshl_b32 s31, s31, 4
  s_cmp_eq_u64 vcc, 0
  s_cselect_b32 s28, 0, 1048576
  s_cmp_eq_u32 s88, 0
  s_cbranch_scc1 L_next
  s_branch L_tail2
.p2align 12
L_ld_end:
  s_max_i32 s98, s98, 0
  s_mov_b32 s88, 1
  s_add_u32 m0, s85, 8448
  s_add_u32 s55, s84, 0
  buffer_load_dwordx4 v22, s[36:39], s55 offen nt lds
  s_waitcnt vmcnt(21)
  s_add_u32 m0, s85, 9504
  s_add_u32 s55, s84, 1024
  buffer_load_dwordx4 v22, s[36:39], s55 offen nt lds
  s_waitcnt vmcnt(21)
  s_add_u32 m0, s85, 10560
  s_add_u32 s55, s84, 2048
  buffer_load_dwordx4 v22, s[36:39], s55 offen nt lds
  s_waitcnt vmcnt(21)
  s_add_u32 m0, s85, 11616
  s_add_u32 s55, s84, 3072
  buffer_load_dwordx4 v22, s[36:39], s55 offen nt lds
  s_waitcnt vmcnt(21)
  s_add_u32 m0, s85, 12672
  s_add_u32 s55, s84, 4096
  buffer_load_dwordx4 v22, s[36:39], s55 offen nt lds
  s_add_u32 s62, s79, -2
  s_max_i32 s81, s81, s62
  v_mov_b32 v10, s81
  s_waitcnt vmcnt(21)
  ds_write_b32 v9, v10 offset:15616
  s_add_u32 m0, s85, 13728
  s_add_u32 s55, s84, 5120
  buffer_load_dwordx4 v22, s[36:39], s55 offen nt lds
  s_waitcnt vmcnt(21)
  s_add_u32 m0, s85, 14784
  s_add_u32 s55, s84, 6144
  buffer_load_dwordx4 v22, s[36:39], s55 offen nt lds
  s_waitcnt vmcnt(21)
  s_add_u32 m0, s85, 15840
  s_add_u32 s55, s84, 7168
  buffer_load_dwordx4 v22, s[36:39], s55 offen nt lds
  s_waitcnt vmcnt(21)
  s_add_u32 m0, s89, 8448
  s_add_u32 s55, s86, 0
  buffer_load_dwordx4 v22, s[36:39], s55 offen nt lds
  s_waitcnt vmcnt(21)
  s_add_u32 m0, s89, 9504
  s_add_u32 s55, s86, 1024
  buffer_load_dwordx4 v22, s[36:39], s55 offen nt lds
  s_waitcnt vmcnt(21)
  s_add_u32 m0, s89, 10560
  s_add_u32 s55, s86, 2048
  buffer_load_dwordx4 v22, s[36:39], s55 offen nt lds
  s_waitcnt vmcnt(21)
  s_add_u32 m0, s89, 11616
  s_add_u32 s55, s86, 3072
  buffer_load_dwordx4 v22, s[36:39], s55 offen nt lds
  s_waitcnt vmcnt(21)
  s_add_u32 m0, s89, 12672
  s_add_u32 s55, s86, 4096
  buffer_load_dwordx4 v22, s[36:39], s55 offen nt lds
  s_add_u32 s62, s79, -1
  s_max_i32 s81, s81, s62
  v_mov_b32 v10, s81
  s_waitcnt vmcnt(21)
  ds_write_b32 v9, v10 offset:15616
  s_add_u32 m0, s89, 13728
  s_add_u32 s55, s86, 5120
  buffer_load_dwordx4 v22, s[36:39], s55 offen nt lds
  s_waitcnt vmcnt(21)
  s_add_u32 m0, s89, 14784
  s_add_u32 s55, s86, 6144
  buffer_load_dwordx4 v22, s[36:39], s55 offen nt lds
  s_waitcnt vmcnt(21)
  s_add_u32 m0, s89, 15840
  s_add_u32 s55, s86, 7168
  buffer_load_dwordx4 v22, s[36:39], s55 offen nt lds
  s_waitcnt vmcnt(21)
  s_add_u32 s62, s79, 0
  s_max_i32 s81, s81, s62
  v_mov_b32 v10, s81
  s_waitcnt vmcnt(16)
  ds_write_b32 v9, v10 offset:15616
  s_add_u32 s62, s79, 2
  s_max_i32 s81, s81, s62
  v_mov_b32 v10, s81
  s_waitcnt vmcnt(8)
  ds_write_b32 v9, v10 offset:15616
  s_add_u32 s62, s79, 4
  s_max_i32 s81, s81, s62
  v_mov_b32 v10, s81
  s_waitcnt vmcnt(0)
  ds_write_b32 v9, v10 offset:15616
  s_setprio 0
  s_waitcnt lgkmcnt(0)
  s_mul_i32 s67, s48, 1664525
  s_add_u32 s67, s67, 1013904223
  s_lshr_b32 s68, s67, 8
  s_lshr_b32 s69, s67, 16
  s_lshr_b32 s70, s67, 24
  s_sub_u32 s62, s72, 3
  s_cmp_lt_u32 s62, 2
  s_cbranch_scc1 L_w2
  s_branch L_cbar
L_done:
L_eg:
  s_sub_u32 s62, s73, s100
  s_min_u32 s62, s62, 6
  s_mul_i32 s63, s62, 2304
  s_cmp_eq_u32 s62, 6
  s_cselect_b32 s63, 16896, s63
  v_mul_u32_u24 v9, 144, v5
  v_lshl_add_u32 v9, v4, 4, v9
  v_add_u32 v9, s63, v9
  s_lshl_b32 s63, 1, s62
  s_mov_b32 exec_lo, 0x11111111
  s_mov_b32 exec_hi, 0x11111111
  ds_write_b128 v9, v[32:35] offset:0
  ds_write_b128 v9, v[36:39] offset:64
  ds_write_b128 v9, v[40:43] offset:128
  ds_write_b128 v9, v[44:47] offset:192
  ds_write_b128 v9, v[48:51] offset:256
  ds_write_b128 v9, v[52:55] offset:320
  ds_write_b128 v9, v[56:59] offset:384
  ds_write_b128 v9, v[60:63] offset:448
  ds_write_b64 v9, v[6:7] offset:512
  v_mov_b32 v10, s63
  s_mov_b64 exec, 1
  ds_or_b32 v83, v10 offset:288
  s_mov_b64 exec, -1
  s_cmp_ge_u32 s62, 4
  s_cbranch_scc1 L_free
  s_add_u32 s101, s62, 1
  s_mov_b32 s73, 0
  s_lshl_b32 s62, s62, 9
  v_add_u32 v14, v4, v5
  v_lshl_add_u32 v14, v14, 4, s62
  s_lshl_b32 s99, s63, 8
  s_setprio 2
  s_waitcnt lgkmcnt(0)
  v_mov_b32 v7, 0
  s_nop 0
  s_branch L_kw
L_hp:
  v_mov_b32 v10, s99
  s_mov_b32 exec_lo, 0x11111111
  s_mov_b32 exec_hi, 0x11111111
  ds_write_b128 v14, v[72:75] offset:19200
  ds_write_b64 v14, v[6:7] offset:19456
  s_mov_b64 exec, 1
  ds_or_b32 v83, v10 offset:288
  s_setprio 0
L_free:
  s_mov_b64 exec, 1
  ds_add_rtn_u32 v13, v83, v85 offset:292
  s_mov_b64 exec, -1
  v_lshrrev_b32 v9, 2, v5
  v_mul_u32_u24 v81, 576, v9
  v_lshl_add_u32 v81, v4, 4, v81
  v_lshlrev_b32 v84, 6, v9
  v_lshl_add_u32 v84, v4, 4, v84
  v_lshlrev_b32 v14, 14, v9
  v_and_b32 v10, 1, v5
  v_lshl_add_u32 v14, v10, 6, v14
  v_lshl_add_u32 v14, v4, 4, v14
  s_waitcnt lgkmcnt(0)
  v_readfirstlane_b32 s66, v13
  s_nop 0
  s_cmp_ge_u32 s66, 4
  s_nop 1
  s_cbranch_scc1 L_cbar
  s_setprio 2
  v_lshlrev_b32 v85, 9, v9
  s_lshl_b32 s62, s66, 7
  v_add_u32 v82, s62, v81
  s_lshl_b32 s64, s58, 11
  s_lshl_b32 s63, s59, 4
  s_add_u32 s64, s64, s63
  s_add_u32 s64, s64, 131072
  s_lshl_b32 s6, s58, 16
  s_lshl_b32 s65, s59, 7
  s_add_u32 s6, s6, s65
  s_lshl_b32 s65, s66, 12
  s_add_u32 s6, s6, s65
  s_add_u32 s6, s6, 524288
  s_add_u32 s7, s6, 1048576
  s_add_u32 s65, s64, 1048576
  s_lshl_b32 s73, s66, 6
  s_add_u32 s73, s73, 22528
  s_mov_b32 s74, 0x07060501
  s_mov_b32 s75, 0x07060502
  s_mov_b32 s76, 0x07060503
  s_mov_b32 s8, 0x11111111
  s_mov_b32 s9, s8
  s_mov_b32 s10, 0x22222222
  s_mov_b32 s11, s10
  s_mov_b32 s12, 0x33333333
  s_mov_b32 s13, s12
  v_mov_b32 v27, s67
  v_mov_b32 v29, s67
  v_mov_b32 v31, s67
  s_mov_b32 s93, 1
  s_mov_b32 s18, 0
  s_mov_b32 s19, 0
  s_mov_b32 s20, 0
  s_add_u32 s62, s100, 4294967295
  s_and_b32 s62, s62, 7
  s_mul_i32 s62, s62, 16896
  s_add_u32 s62, s62, s73
  v_add_u32 v60, s62, v80
  s_mov_b32 s14, 0
  s_add_u32 s62, s100, 0
  s_and_b32 s62, s62, 7
  s_mul_i32 s62, s62, 16896
  s_add_u32 s62, s62, s73
  v_add_u32 v61, s62, v80
  s_mov_b32 s15, 0
  s_add_u32 s62, s100, 1
  s_and_b32 s62, s62, 7
  s_mul_i32 s62, s62, 16896
  s_add_u32 s62, s62, s73
  v_add_u32 v62, s62, v80
  s_mov_b32 s16, 0
  s_add_u32 s62, s100, 2
  s_and_b32 s62, s62, 7
  s_mul_i32 s62, s62, 16896
  s_add_u32 s62, s62, s73
  v_add_u32 v63, s62, v80
  s_mov_b32 s17, 0
  s_cmp_ge_u32 s66, 0
  s_cbranch_scc1 L_odry
L_ob:
  ds_read2_b32 v[10:11], v83 offset0:0 offset1:72
  s_sub_u32 s98, s98, 1
  s_cbranch_scc1 L_ob_to
  s_waitcnt lgkmcnt(0)
  v_readfirstlane_b32 s63, v11
  v_readfirstlane_b32 s62, v10
  s_andn2_b32 s63, s18, s63
  s_nop 2
  s_cbranch_scc0 L_ob_ok
  s_sleep 1
  s_branch L_ob
L_ob_to:
  s_mov_b32 s98, 0
L_ob_ok:
  ds_read_b64 v[40:41], v81 offset:512
  ds_read_b64 v[42:43], v81 offset:2816
  ds_read_b64 v[44:45], v81 offset:5120
  ds_read_b64 v[46:47], v81 offset:7424
  ds_read_b64 v[48:49], v81 offset:9728
  ds_read_b64 v[50:51], v81 offset:12032
  ds_read_b64 v[52:53], v81 offset:17408
  ds_read_b64 v[54:55], v84 offset:19456
  ds_read_b64 v[56:57], v84 offset:19968
  ds_read_b128 v[96:99], v82 offset:0
  ds_read_b128 v[100:103], v82 offset:64
  ds_read_b128 v[104:107], v82 offset:2304
  ds_read_b128 v[108:111], v82 offset:2368
  ds_read_b128 v[112:115], v82 offset:4608
  ds_read_b128 v[116:119], v82 offset:4672
  ds_read_b128 v[120:123], v82 offset:6912
  ds_read_b128 v[124:127], v82 offset:6976
  ds_read_b128 v[128:131], v82 offset:9216
  ds_read_b128 v[132:135], v82 offset:9280
  ds_read_b128 v[136:139], v82 offset:11520
  ds_read_b128 v[140:143], v82 offset:11584
  ds_read_b128 v[144:147], v82 offset:16896
  ds_read_b128 v[148:151], v82 offset:16960
  s_waitcnt lgkmcnt(14)
  v_max3_f32 v6, v40, v42, v44
  v_max3_f32 v6, v6, v46, v48
  v_max3_f32 v6, v6, v50, v52
  v_max3_f32 v6, v6, v54, v56
  ds_read_b128 v[64:67], v84 offset:19200
  ds_read_b128 v[68:71], v84 offset:19712
  v_sub_f32 v40, v40, v6
  v_sub_f32 v42, v42, v6
  v_sub_f32 v44, v44, v6
  v_sub_f32 v46, v46, v6
  v_sub_f32 v48, v48, v6
  v_sub_f32 v50, v50, v6
  v_sub_f32 v52, v52, v6
  v_sub_f32 v54, v54, v6
  v_sub_f32 v56, v56, v6
  v_mul_f32 v40, s52, v40
  v_mul_f32 v42, s52, v42
  v_mul_f32 v44, s52, v44
  v_mul_f32 v46, s52, v46
  v_mul_f32 v48, s52, v48
  v_mul_f32 v50, s52, v50
  v_mul_f32 v52, s52, v52
  v_mul_f32 v54, s52, v54
  v_mul_f32 v56, s52, v56
  v_exp_f32 v40, v40
  v_exp_f32 v42, v42
  v_exp_f32 v44, v44
  v_exp_f32 v46, v46
  v_exp_f32 v48, v48
  v_exp_f32 v50, v50
  v_exp_f32 v52, v52
  v_exp_f32 v54, v54
  v_exp_f32 v56, v56
  v_mul_f32 v7, v40, v41
  v_fmac_f32 v7, v42, v43
  v_fmac_f32 v7, v44, v45
  v_fmac_f32 v7, v46, v47
  v_fmac_f32 v7, v48, v49
  v_fmac_f32 v7, v50, v51
  v_fmac_f32 v7, v52, v53
  v_fmac_f32 v7, v54, v55
  v_fmac_f32 v7, v56, v57
  s_waitcnt lgkmcnt(0)
  v_pk_mul_f32 v[32:33], v[40:41], v[96:97] op_sel_hi:[0,1]
  v_pk_mul_f32 v[34:35], v[40:41], v[98:99] op_sel_hi:[0,1]
  v_pk_mul_f32 v[36:37], v[40:41], v[100:101] op_sel_hi:[0,1]
  v_pk_mul_f32 v[38:39], v[40:41], v[102:103] op_sel_hi:[0,1]
  v_pk_fma_f32 v[32:33], v[42:43], v[104:105], v[32:33] op_sel_hi:[0,1,1]
  v_pk_fma_f32 v[34:35], v[42:43], v[106:107], v[34:35] op_sel_hi:[0,1,1]
  v_pk_fma_f32 v[36:37], v[42:43], v[108:109], v[36:37] op_sel_hi:[0,1,1]
  v_pk_fma_f32 v[38:39], v[42:43], v[110:111], v[38:39] op_sel_hi:[0,1,1]
  v_pk_fma_f32 v[32:33], v[44:45], v[112:113], v[32:33] op_sel_hi:[0,1,1]
  v_pk_fma_f32 v[34:35], v[44:45], v[114:115], v[34:35] op_sel_hi:[0,1,1]
  v_pk_fma_f32 v[36:37], v[44:45], v[116:117], v[36:37] op_sel_hi:[0,1,1]
  v_pk_fma_f32 v[38:39], v[44:45], v[118:119], v[38:39] op_sel_hi:[0,1,1]
  v_pk_fma_f32 v[32:33], v[46:47], v[120:121], v[32:33] op_sel_hi:[0,1,1]
  v_pk_fma_f32 v[34:35], v[46:47], v[122:123], v[34:35] op_sel_hi:[0,1,1]
  v_pk_fma_f32 v[36:37], v[46:47], v[124:125], v[36:37] op_sel_hi:[0,1,1]
  v_pk_fma_f32 v[38:39], v[46:47], v[126:127], v[38:39] op_sel_hi:[0,1,1]
  v_pk_fma_f32 v[32:33], v[48:49], v[128:129], v[32:33] op_sel_hi:[0,1,1]
  v_pk_fma_f32 v[34:35], v[48:49], v[130:131], v[34:35] op_sel_hi:[0,1,1]
  v_pk_fma_f32 v[36:37], v[48:49], v[132:133], v[36:37] op_sel_hi:[0,1,1]
  v_pk_fma_f32 v[38:39], v[48:49], v[134:135], v[38:39] op_sel_hi:[0,1,1]
  v_pk_fma_f32 v[32:33], v[50:51], v[136:137], v[32:33] op_sel_hi:[0,1,1]
  v_pk_fma_f32 v[34:35], v[50:51], v[138:139], v[34:35] op_sel_hi:[0,1,1]
  v_pk_fma_f32 v[36:37], v[50:51], v[140:141], v[36:37] op_sel_hi:[0,1,1]
  v_pk_fma_f32 v[38:39], v[50:51], v[142:143], v[38:39] op_sel_hi:[0,1,1]
  v_pk_fma_f32 v[32:33], v[52:53], v[144:145], v[32:33] op_sel_hi:[0,1,1]
  v_pk_fma_f32 v[34:35], v[52:53], v[146:147], v[34:35] op_sel_hi:[0,1,1]
  v_pk_fma_f32 v[36:37], v[52:53], v[148:149], v[36:37] op_sel_hi:[0,1,1]
  v_pk_fma_f32 v[38:39], v[52:53], v[150:151], v[38:39] op_sel_hi:[0,1,1]
L_oa:
  ds_read2_b32 v[10:11], v83 offset0:0 offset1:72
  s_sub_u32 s98, s98, 1
  s_cbranch_scc1 L_oa_to
  s_waitcnt lgkmcnt(0)
  v_readfirstlane_b32 s63, v11
  v_readfirstlane_b32 s62, v10
  s_andn2_b32 s63, s20, s63
  s_nop 2
  s_cbranch_scc0 L_oa_ok
  s_branch L_oa
L_oa_to:
  s_mov_b32 s98, 0
L_oa_ok:
  ds_read_b64 v[58:59], v84 offset:20480
  ds_read_b128 v[72:75], v84 offset:20224
  s_waitcnt lgkmcnt(1)
  v_max_f32 v11, v6, v58
  v_sub_f32 v10, v6, v11
  v_sub_f32 v58, v58, v11
  v_mul_f32 v10, s52, v10
  v_mul_f32 v58, s52, v58
  v_exp_f32 v10, v10
  v_exp_f32 v58, v58
  v_mul_f32 v7, v10, v7
  v_mov_b32 v6, v11
  v_fmac_f32 v7, v58, v59
  v_pk_mul_f32 v[32:33], v[10:11], v[32:33] op_sel_hi:[0,1]
  v_pk_mul_f32 v[34:35], v[10:11], v[34:35] op_sel_hi:[0,1]
  v_pk_mul_f32 v[36:37], v[10:11], v[36:37] op_sel_hi:[0,1]
  v_pk_mul_f32 v[38:39], v[10:11], v[38:39] op_sel_hi:[0,1]
  v_mul_f32 v54, v10, v54
  v_mul_f32 v56, v10, v56
  s_cmp_ge_i32 s62, s14
  s_cbranch_scc1 L_ov0_ok
L_ov0:
  ds_read_b32 v10, v83
  s_sub_u32 s98, s98, 1
  s_cbranch_scc1 L_ov0_to
  s_waitcnt lgkmcnt(0)
  v_readfirstlane_b32 s62, v10
  s_nop 0
  s_cmp_lt_i32 s62, s14
  s_nop 1
  s_cbranch_scc1 L_ov0
L_ov0_to:
  s_max_i32 s98, s98, 0
L_ov0_ok:
  ds_read_b64_tr_b16 v[152:153], v60 offset:0
  ds_read_b64_tr_b16 v[154:155], v60 offset:512
  ds_read_b64_tr_b16 v[156:157], v60 offset:32
  ds_read_b64_tr_b16 v[158:159], v60 offset:544
  s_waitcnt lgkmcnt(2)
  v_mfma_f32_16x16x32_bf16 v[96:99], v[152:155], v[64:67], 0
  s_waitcnt lgkmcnt(0)
  v_mfma_f32_16x16x32_bf16 v[100:103], v[156:159], v[64:67], 0
  s_cmp_ge_i32 s62, s15
  s_nop 5
  s_cbranch_scc1 L_ov1_ok
L_ov1:
  ds_read_b32 v10, v83
  s_sub_u32 s98, s98, 1
  s_cbranch_scc1 L_ov1_to
  s_waitcnt lgkmcnt(0)
  v_readfirstlane_b32 s62, v10
  s_nop 0
  s_cmp_lt_i32 s62, s15
  s_nop 1
  s_cbranch_scc1 L_ov1
L_ov1_to:
  s_max_i32 s98, s98, 0
L_ov1_ok:
  ds_read_b64_tr_b16 v[152:153], v61 offset:0
  ds_read_b64_tr_b16 v[154:155], v61 offset:512
  ds_read_b64_tr_b16 v[156:157], v61 offset:32
  ds_read_b64_tr_b16 v[158:159], v61 offset:544
  v_pk_fma_f32 v[32:33], v[54:55], v[96:97], v[32:33] op_sel_hi:[0,1,1]
  v_pk_fma_f32 v[34:35], v[54:55], v[98:99], v[34:35] op_sel_hi:[0,1,1]
  v_pk_fma_f32 v[36:37], v[54:55], v[100:101], v[36:37] op_sel_hi:[0,1,1]
  v_pk_fma_f32 v[38:39], v[54:55], v[102:103], v[38:39] op_sel_hi:[0,1,1]
  s_waitcnt lgkmcnt(2)
  v_mfma_f32_16x16x32_bf16 v[104:107], v[152:155], v[68:71], 0
  s_waitcnt lgkmcnt(0)
  v_mfma_f32_16x16x32_bf16 v[108:111], v[156:159], v[68:71], 0
  s_cmp_ge_i32 s62, s16
  s_nop 5
  s_cbranch_scc1 L_ov2_ok
L_ov2:
  ds_read_b32 v10, v83
  s_sub_u32 s98, s98, 1
  s_cbranch_scc1 L_ov2_to
  s_waitcnt lgkmcnt(0)
  v_readfirstlane_b32 s62, v10
  s_nop 0
  s_cmp_lt_i32 s62, s16
  s_nop 1
  s_cbranch_scc1 L_ov2
L_ov2_to:
  s_max_i32 s98, s98, 0
L_ov2_ok:
  ds_read_b64_tr_b16 v[152:153], v62 offset:0
  ds_read_b64_tr_b16 v[154:155], v62 offset:512
  ds_read_b64_tr_b16 v[156:157], v62 offset:32
  ds_read_b64_tr_b16 v[158:159], v62 offset:544
  v_pk_fma_f32 v[32:33], v[56:57], v[104:105], v[32:33] op_sel_hi:[0,1,1]
  v_pk_fma_f32 v[34:35], v[56:57], v[106:107], v[34:35] op_sel_hi:[0,1,1]
  v_pk_fma_f32 v[36:37], v[56:57], v[108:109], v[36:37] op_sel_hi:[0,1,1]
  v_pk_fma_f32 v[38:39], v[56:57], v[110:111], v[38:39] op_sel_hi:[0,1,1]
  s_waitcnt lgkmcnt(2)
  v_mfma_f32_16x16x32_bf16 v[112:115], v[152:155], v[72:75], 0
  s_waitcnt lgkmcnt(0)
  v_mfma_f32_16x16x32_bf16 v[116:119], v[156:159], v[72:75], 0
L_oc:
  ds_read2_b32 v[10:11], v83 offset0:0 offset1:72
  s_sub_u32 s98, s98, 1
  s_nop 4
  s_cbranch_scc1 L_oc_to
  s_waitcnt lgkmcnt(0)
  v_readfirstlane_b32 s63, v11
  v_readfirstlane_b32 s62, v10
  s_andn2_b32 s63, s19, s63
  s_nop 2
  s_cbranch_scc0 L_oc_ok
  s_branch L_oc
L_oc_to:
  s_mov_b32 s98, 0
L_oc_ok:
  ds_read_b64 v[8:9], v84 offset:20992
  ds_read_b128 v[76:79], v84 offset:20736
  v_pk_fma_f32 v[32:33], v[58:59], v[112:113], v[32:33] op_sel_hi:[0,1,1]
  v_pk_fma_f32 v[34:35], v[58:59], v[114:115], v[34:35] op_sel_hi:[0,1,1]
  v_pk_fma_f32 v[36:37], v[58:59], v[116:117], v[36:37] op_sel_hi:[0,1,1]
  v_pk_fma_f32 v[38:39], v[58:59], v[118:119], v[38:39] op_sel_hi:[0,1,1]
  s_or_b32 s63, s66, s93
  s_waitcnt lgkmcnt(1)
  v_max_f32 v28, v6, v8
  v_sub_f32 v10, v6, v28
  v_sub_f32 v8, v8, v28
  v_mul_f32 v10, s52, v10
  v_mul_f32 v8, s52, v8
  v_exp_f32 v10, v10
  v_exp_f32 v8, v8
  v_mul_f32 v30, v10, v7
  v_fmac_f32 v30, v8, v9
  v_pk_mul_f32 v[32:33], v[10:11], v[32:33] op_sel_hi:[0,1]
  v_pk_mul_f32 v[34:35], v[10:11], v[34:35] op_sel_hi:[0,1]
  v_pk_mul_f32 v[36:37], v[10:11], v[36:37] op_sel_hi:[0,1]
  v_pk_mul_f32 v[38:39], v[10:11], v[38:39] op_sel_hi:[0,1]
  s_nop 0
  s_cbranch_scc1 L_ons
  v_mov_b32 v7, v30
  s_nop 1
  v_permlane16_swap_b32 v30, v7
  v_add_f32 v30, v30, v7
  v_mov_b32 v7, v30
  s_nop 1
  v_permlane32_swap_b32 v30, v7
  v_add_f32 v30, v30, v7
  s_mov_b64 exec, 0x1111
  buffer_store_dwordx4 v[28:31], v85, s[40:43], s64 offen
  s_mov_b64 exec, -1
L_ons:
  s_cmp_ge_i32 s62, s17
  s_cbranch_scc1 L_ovl_ok
L_ovl:
  ds_read_b32 v10, v83
  s_sub_u32 s98, s98, 1
  s_cbranch_scc1 L_ovl_to
  s_waitcnt lgkmcnt(0)
  v_readfirstlane_b32 s62, v10
  s_nop 0
  s_cmp_lt_i32 s62, s17
  s_nop 1
  s_cbranch_scc1 L_ovl
L_ovl_to:
  s_max_i32 s98, s98, 0
L_ovl_ok:
  ds_read_b64_tr_b16 v[152:153], v63 offset:0
  ds_read_b64_tr_b16 v[154:155], v63 offset:512
  ds_read_b64_tr_b16 v[156:157], v63 offset:32
  ds_read_b64_tr_b16 v[158:159], v63 offset:544
  s_cmp_lg_u32 s93, 0
  s_waitcnt lgkmcnt(2)
  v_mfma_f32_16x16x32_bf16 v[16:19], v[152:155], v[76:79], 0
  s_waitcnt lgkmcnt(0)
  v_mfma_f32_16x16x32_bf16 v[20:23], v[156:159], v[76:79], 0
  s_nop 5
  v_pk_fma_f32 v[32:33], v[8:9], v[16:17], v[32:33] op_sel_hi:[0,1,1]
  v_pk_fma_f32 v[34:35], v[8:9], v[18:19], v[34:35] op_sel_hi:[0,1,1]
  s_mov_b64 exec, s[8:9]
  v_perm_b32 v24, v32, v35, s74
  v_perm_b32 v25, v33, v35, s75
  v_perm_b32 v26, v34, v35, s76
  s_mov_b64 exec, s[12:13]
  v_pk_fma_f32 v[36:37], v[8:9], v[20:21], v[36:37] op_sel_hi:[0,1,1]
  v_pk_fma_f32 v[38:39], v[8:9], v[22:23], v[38:39] op_sel_hi:[0,1,1]
  s_mov_b64 exec, s[10:11]
  v_perm_b32 v24, v36, v39, s74
  v_perm_b32 v25, v37, v39, s75
  v_perm_b32 v26, v38, v39, s76
  s_mov_b64 exec, s[12:13]
  s_cbranch_scc1 L_odry
  buffer_store_dwordx4 v[24:27], v14, s[40:43], s6 offen
  s_cmp_eq_u32 s94, 0
  s_cbranch_scc1 L_oe
  buffer_store_dwordx4 v[24:27], v14, s[40:43], s7 offen sc1
  s_cmp_lg_u32 s66, 0
  s_cbranch_scc1 L_oe
  s_mov_b64 exec, 0x1111
  buffer_store_dwordx4 v[28:31], v85, s[40:43], s65 offen sc1
L_oe:
  s_mov_b64 exec, -1
  s_setprio 0
  s_branch L_cbar
L_odry:
  s_mov_b64 exec, -1
  s_mov_b32 s93, 0
  s_mov_b32 s18, 895
  s_mov_b32 s20, 1024
  s_mov_b32 s19, 2048
  s_lshl_b32 s62, s100, 1
  s_add_u32 s14, s62, 2
  s_add_u32 s15, s62, 4
  s_add_u32 s16, s62, 6
  s_add_u32 s17, s62, 8
  s_branch L_ob
L_cbar:
  s_mov_b32 s74, 0x07060501
  s_mov_b32 s75, 0x07060502
  s_mov_b32 s76, 0x07060503
  s_waitcnt lgkmcnt(0)
  s_barrier
  s_branch L_tail
.p2align 12
L_tail:
  s_sub_u32 s62, s72, 3
  s_cmp_ge_u32 s62, 2
  s_cbranch_scc1 L_endt
  s_cmp_lg_u32 s88, 0
  s_cbranch_scc1 L_prep
L_tail2:
  s_cmp_eq_u32 s72, 4
  s_cbranch_scc1 L_ffn
  s_lshr_b32 s62, s60, 2
  s_lshl_b32 s64, s58, 16
  s_lshl_b32 s63, s62, 15
  s_add_u32 s64, s64, s63
  s_lshl_b32 s63, s3, 12
  s_add_u32 s64, s64, s63
  s_add_u32 s64, s64, 524288
  s_lshl_b32 s65, s58, 11
  s_lshl_b32 s63, s62, 10
  s_add_u32 s65, s65, s63
  s_lshr_b32 s63, s3, 2
  s_lshl_b32 s63, s63, 9
  s_add_u32 s65, s65, s63
  s_add_u32 s65, s65, 131072
  s_add_u32 s78, s64, s28
  s_add_u32 s79, s65, s28
  s_lshl_b32 s66, s58, 7
  s_add_u32 s66, s66, 26624
  v_and_b32 v9, 3, v1
  v_lshrrev_b32 v11, 3, v1
  v_lshl_add_u32 v10, v9, 3, v11
  v_lshlrev_b32 v10, 4, v10
  v_lshlrev_b32 v9, 2, v9
  v_lshl_add_u32 v9, v11, 4, v9
  s_lshl_b32 s63, s3, 9
  s_add_u32 s63, s63, 16896
  v_lshlrev_b32 v14, 5, v5
  v_lshl_add_u32 v14, v4, 3, v14
  v_add_u32 v14, s63, v14
  s_lshl_b32 s85, s58, 12
  s_lshl_b32 s63, s60, 9
  s_add_u32 s85, s85, s63
  s_add_u32 s85, s85, 163840
  s_mov_b32 s73, 0x0c04000c
  s_not_b32 s62, s67
  s_mov_b32 s61, 0
  s_cmp_lg_u32 s28, 0
  s_cselect_b32 s99, 1, 1
  v_mov_b32 v167, s67
  v_mov_b32 v131, s62
  v_mov_b32 v135, s62
  v_mov_b32 v139, s62
  v_mov_b32 v143, s62
  v_mov_b32 v161, s62
L_wo_poll:
  s_waitcnt vmcnt(0)
  v_cmp_ne_u32 s[6:7], s67, v131
  v_cmp_ne_u32 s[8:9], s67, v135
  v_cmp_ne_u32 s[10:11], s67, v139
  v_cmp_ne_u32 s[12:13], s67, v143
  v_cmp_ne_u32 s[14:15], s67, v161
  s_or_b64 s[62:63], s[6:7], s[8:9]
  s_or_b64 s[62:63], s[62:63], s[10:11]
  s_or_b64 s[62:63], s[62:63], s[12:13]
  s_or_b64 s[62:63], s[62:63], s[14:15]
  s_cbranch_scc0 L_wo_ok
  s_and_b64 exec, s[6:7], s[6:7]
  s_cbranch_scc0 L_wo_s0
  buffer_load_dwordx4 v[128:131], v3, s[40:43], s78 offen offset:0 sc1
L_wo_s0:
  s_and_b64 exec, s[8:9], s[8:9]
  s_cbranch_scc0 L_wo_s1
  buffer_load_dwordx4 v[132:135], v3, s[40:43], s78 offen offset:1024 sc1
L_wo_s1:
  s_and_b64 exec, s[10:11], s[10:11]
  s_cbranch_scc0 L_wo_s2
  buffer_load_dwordx4 v[136:139], v3, s[40:43], s78 offen offset:2048 sc1
L_wo_s2:
  s_and_b64 exec, s[12:13], s[12:13]
  s_cbranch_scc0 L_wo_s3
  buffer_load_dwordx4 v[140:143], v3, s[40:43], s78 offen offset:3072 sc1
L_wo_s3:
  s_and_b64 exec, s[14:15], s[14:15]
  s_cbranch_scc0 L_wo_s4
  buffer_load_dwordx4 v[160:163], v10, s[40:43], s79 offen sc1
L_wo_s4:
  s_mov_b64 exec, -1
  s_add_u32 s61, s61, 1
L_wo_nf:
  s_cmp_lt_u32 s61, s97
  s_cbranch_scc1 L_wo_poll
  s_waitcnt vmcnt(0)
L_wo_ok:
  v_max_f32_dpp v11, v160, v160 row_ror:8 row_mask:0xf bank_mask:0xf
  v_perm_b32 v131, v129, v128, s73
  v_perm_b32 v135, v133, v132, s73
  v_max_f32_dpp v11, v11, v11 quad_perm:[1,0,3,2] row_mask:0xf bank_mask:0xf
  v_perm_b32 v139, v137, v136, s73
  v_perm_b32 v143, v141, v140, s73
  v_max_f32_dpp v11, v11, v11 quad_perm:[2,3,0,1] row_mask:0xf bank_mask:0xf
  v_mov_b32 v12, v11
  v_lshl_or_b32 v131, v130, 24, v131
  v_lshl_or_b32 v135, v134, 24, v135
  v_permlane16_swap_b32 v11, v12
  v_max_f32 v11, v11, v12
  v_mov_b32 v12, v11
  v_lshl_or_b32 v139, v138, 24, v139
  v_lshl_or_b32 v143, v142, 24, v143
  v_permlane32_swap_b32 v11, v12
  v_max_f32 v11, v11, v12
  v_sub_f32 v160, v160, v11
  v_mul_f32 v160, s52, v160
  v_exp_f32 v160, v160
  s_nop 0
  v_mul_f32 v162, v160, v162
  v_mul_f32_dpp v96, v160, v128 quad_perm:[0,0,0,0] row_mask:0xf bank_mask:0xf
  v_mul_f32_dpp v97, v160, v129 quad_perm:[0,0,0,0] row_mask:0xf bank_mask:0xf
  v_add_f32_dpp v162, v162, v162 row_ror:8 row_mask:0xf bank_mask:0xf
  v_mul_f32_dpp v98, v160, v130 quad_perm:[0,0,0,0] row_mask:0xf bank_mask:0xf
  v_mul_f32_dpp v99, v160, v131 quad_perm:[0,0,0,0] row_mask:0xf bank_mask:0xf
  v_add_f32_dpp v162, v162, v162 quad_perm:[1,0,3,2] row_mask:0xf bank_mask:0xf
  v_fmac_f32_dpp v96, v160, v132 quad_perm:[1,1,1,1] row_mask:0xf bank_mask:0xf
  v_fmac_f32_dpp v97, v160, v133 quad_perm:[1,1,1,1] row_mask:0xf bank_mask:0xf
  v_add_f32_dpp v162, v162, v162 quad_perm:[2,3,0,1] row_mask:0xf bank_mask:0xf
  v_fmac_f32_dpp v98, v160, v134 quad_perm:[1,1,1,1] row_mask:0xf bank_mask:0xf
  v_fmac_f32_dpp v99, v160, v135 quad_perm:[1,1,1,1] row_mask:0xf bank_mask:0xf
  v_mov_b32 v12, v162
  v_fmac_f32_dpp v96, v160, v136 quad_perm:[2,2,2,2] row_mask:0xf bank_mask:0xf
  v_fmac_f32_dpp v97, v160, v137 quad_perm:[2,2,2,2] row_mask:0xf bank_mask:0xf
  v_permlane16_swap_b32 v162, v12
  v_fmac_f32_dpp v98, v160, v138 quad_perm:[2,2,2,2] row_mask:0xf bank_mask:0xf
  v_fmac_f32_dpp v99, v160, v139 quad_perm:[2,2,2,2] row_mask:0xf bank_mask:0xf
  v_add_f32 v162, v162, v12
  v_fmac_f32_dpp v96, v160, v140 quad_perm:[3,3,3,3] row_mask:0xf bank_mask:0xf
  v_fmac_f32_dpp v97, v160, v141 quad_perm:[3,3,3,3] row_mask:0xf bank_mask:0xf
  v_mov_b32 v12, v162
  v_fmac_f32_dpp v98, v160, v142 quad_perm:[3,3,3,3] row_mask:0xf bank_mask:0xf
  v_fmac_f32_dpp v99, v160, v143 quad_perm:[3,3,3,3] row_mask:0xf bank_mask:0xf
  v_permlane32_swap_b32 v162, v12
  v_permlane32_swap_b32 v96, v98
  v_permlane32_swap_b32 v97, v99
  v_add_f32 v162, v162, v12
  v_add_f32 v96, v96, v98
  v_add_f32 v97, v97, v99
  v_rcp_f32 v163, v162
  s_nop 0
  v_permlane16_swap_b32 v96, v97
  v_add_f32 v96, v96, v97
  s_nop 1
  v_add_f32_dpp v96, v96, v96 row_ror:8 row_mask:0xf bank_mask:0xf
  v_mul_f32 v96, v96, v163
  s_nop 1
  v_mov_b32_dpp v73, v96 row_shl:1 row_mask:0xf bank_mask:0xf
  v_cvt_pk_bf16_f32 v76, v96, v73
  s_nop 1
  v_mov_b32_dpp v72, v76 row_newbcast:0 row_mask:0xf bank_mask:0xf
  v_mov_b32_dpp v73, v76 row_newbcast:2 row_mask:0xf bank_mask:0xf
  v_mov_b32_dpp v74, v76 row_newbcast:4 row_mask:0xf bank_mask:0xf
  v_mov_b32_dpp v75, v76 row_newbcast:6 row_mask:0xf bank_mask:0xf
  s_nop 1
  v_mfma_f32_16x16x32_bf16 v[32:35], v[72:75], v[224:227], 0
  v_mfma_f32_16x16x32_bf16 v[36:39], v[72:75], v[228:231], 0
  v_mfma_f32_16x16x32_bf16 v[40:43], v[72:75], v[232:235], 0
  v_mfma_f32_16x16x32_bf16 v[44:47], v[72:75], v[236:239], 0
  v_mfma_f32_16x16x32_bf16 v[48:51], v[72:75], v[240:243], 0
  v_mfma_f32_16x16x32_bf16 v[52:55], v[72:75], v[244:247], 0
  v_mfma_f32_16x16x32_bf16 v[56:59], v[72:75], v[248:251], 0
  v_mfma_f32_16x16x32_bf16 v[60:63], v[72:75], v[252:255], 0
  s_nop 2
  v_mov_b32_dpp v32, v40 quad_perm:[0,1,2,3] row_mask:2 bank_mask:0xf
  v_mov_b32_dpp v36, v44 quad_perm:[0,1,2,3] row_mask:2 bank_mask:0xf
  s_nop 0
  v_mov_b32_dpp v32, v48 quad_perm:[0,1,2,3] row_mask:4 bank_mask:0xf
  v_mov_b32_dpp v36, v52 quad_perm:[0,1,2,3] row_mask:4 bank_mask:0xf
  s_nop 0
  v_mov_b32_dpp v32, v56 quad_perm:[0,1,2,3] row_mask:8 bank_mask:0xf
  v_mov_b32_dpp v36, v60 quad_perm:[0,1,2,3] row_mask:8 bank_mask:0xf
  ds_write2_b32 v14, v32, v36 offset0:0 offset1:1
  s_cmp_lg_u32 s3, 0
  s_waitcnt lgkmcnt(0)
  s_barrier
  s_cbranch_scc1 L_final
  s_mov_b32 exec_hi, 0
  ds_read_b128 v[32:35], v3 offset:16896
  ds_read_b128 v[36:39], v3 offset:17408
  ds_read_b128 v[40:43], v3 offset:17920
  ds_read_b128 v[44:47], v3 offset:18432
  ds_read_b128 v[48:51], v3 offset:18944
  ds_read_b128 v[52:55], v3 offset:19456
  ds_read_b128 v[56:59], v3 offset:19968
  ds_read_b128 v[60:63], v3 offset:20480
  s_waitcnt lgkmcnt(4)
  v_pk_add_f32 v[32:33], v[32:33], v[40:41]
  v_pk_add_f32 v[34:35], v[34:35], v[42:43]
  v_pk_add_f32 v[36:37], v[36:37], v[44:45]
  v_pk_add_f32 v[38:39], v[38:39], v[46:47]
  s_waitcnt lgkmcnt(0)
  v_pk_add_f32 v[48:49], v[48:49], v[56:57]
  v_pk_add_f32 v[50:51], v[50:51], v[58:59]
  v_pk_add_f32 v[52:53], v[52:53], v[60:61]
  v_pk_add_f32 v[54:55], v[54:55], v[62:63]
  v_pk_add_f32 v[32:33], v[32:33], v[48:49]
  v_pk_add_f32 v[34:35], v[34:35], v[50:51]
  v_pk_add_f32 v[36:37], v[36:37], v[52:53]
  v_pk_add_f32 v[38:39], v[38:39], v[54:55]
  v_pk_add_f32 v[32:33], v[32:33], v[36:37]
  v_pk_add_f32 v[34:35], v[34:35], v[38:39]
  v_perm_b32 v164, v32, v35, s74
  v_perm_b32 v165, v33, v35, s75
  v_perm_b32 v166, v34, v35, s76
  buffer_store_dwordx4 v[164:167], v3, s[40:43], s85 offen sc1
  s_endpgm
L_final:
  s_cmp_lg_u32 s3, 1
  s_cbranch_scc1 L_endt
  s_mov_b32 s44, s26
  s_mov_b32 s45, s27
  s_lshr_b32 s46, s42, 19
  s_cmp_ge_u32 s60, 4
  s_cbranch_scc1 L_endt
  s_lshl_b32 s62, s31, 2
  v_and_b32 v10, 3, v1
  v_lshlrev_b32 v10, 4, v10
  v_lshrrev_b32 v9, 2, v1
  v_lshl_add_u32 v9, v9, 11, v10
  s_add_u32 s63, s62, 163840
  s_add_u32 s64, s62, 196608
  s_add_u32 s65, s62, 225280
  v_mov_b32 v96, 0
  v_mov_b32 v97, 0
  v_mov_b32 v98, 0
  v_mov_b32 v99, 0
  v_mov_b32 v100, 0
  v_mov_b32 v101, 0
  v_mov_b32 v102, 0
  v_mov_b32 v103, 0
  s_mov_b32 s61, s97
L_a_poll:
  buffer_load_dwordx4 v[96:99], v9, s[40:43], s63 offen sc1
  s_waitcnt vmcnt(0)
  v_cmp_ne_u32 vcc, s67, v99
  s_nop 0
  s_and_b64 exec, vcc, vcc
  s_nop 1
  s_cbranch_scc0 L_a_poll_ok
  s_sub_u32 s61, s61, 1
  s_cmp_lg_u32 s61, 0
  s_cbranch_scc1 L_a_poll
L_a_poll_ok:
  s_mov_b64 exec, -1
  v_perm_b32 v99, v97, v96, s73
  v_lshl_or_b32 v99, v98, 24, v99
  v_permlane32_swap_b32 v96, v98
  s_nop 0
  v_permlane32_swap_b32 v97, v99
  v_add_f32 v96, v96, v98
  v_add_f32 v97, v97, v99
  s_nop 1
  v_permlane16_swap_b32 v96, v97
  v_add_f32 v96, v96, v97
  s_nop 1
  v_add_f32_dpp v96, v96, v96 row_ror:8 row_mask:0xf bank_mask:0xf
  s_nop 1
  v_add_f32_dpp v96, v96, v96 row_ror:4 row_mask:0xf bank_mask:0xf
  v_cvt_pk_bf16_f32 v96, 0, v96
  v_mul_f32 v96, v91, v96
  v_cvt_pk_bf16_f32 v96, 0, v96
  v_add_f32 v90, v90, v96
  v_cvt_pk_bf16_f32 v90, 0, v90
  s_cmp_lg_u32 s31, 0
  s_cbranch_scc1 L_y_again
  s_mov_b64 exec, 1
  v_mov_b32 v10, 0
  v_mov_b32 v11, s67
  buffer_store_dword v11, v10, s[40:43], 0 offen sc1
  s_mov_b64 exec, -1
L_y_again:
  v_mov_b32 v96, 0
  v_mov_b32 v97, 0
  v_mov_b32 v98, 0
  v_mov_b32 v99, 0
  s_mov_b32 exec_hi, 0x00ffffff
  s_mov_b32 s61, s97
L_y_poll:
  buffer_load_dwordx4 v[96:99], v9, s[40:43], s64 offen sc1
  buffer_load_dwordx4 v[100:103], v9, s[40:43], s65 offen sc1
  s_waitcnt vmcnt(0)
  v_xor_b32 v11, s67, v96
  v_bitop3_b32 v11, v11, v97, s68 bitop3:0xf6
  v_bitop3_b32 v11, v11, v98, s69 bitop3:0xf6
  v_bitop3_b32 v11, v11, v99, s70 bitop3:0xf6
  v_bitop3_b32 v11, v11, v100, s67 bitop3:0xf6
  v_bitop3_b32 v11, v11, v101, s68 bitop3:0xf6
  v_bitop3_b32 v11, v11, v102, s69 bitop3:0xf6
  v_bitop3_b32 v11, v11, v103, s70 bitop3:0xf6
  v_and_b32 v11, 0xff, v11
  v_cmp_ne_u32 vcc, 0, v11
  s_nop 0
  s_and_b64 exec, vcc, vcc
  s_nop 1
  s_cbranch_scc0 L_y_poll_ok
  s_sub_u32 s61, s61, 1
  s_cmp_lg_u32 s61, 0
  s_cbranch_scc1 L_y_poll
L_y_poll_ok:
  s_mov_b64 exec, -1
  v_pk_add_f32 v[96:97], v[96:97], v[100:101]
  v_pk_add_f32 v[98:99], v[98:99], v[102:103]
  s_nop 1
  v_permlane32_swap_b32 v96, v98
  v_permlane32_swap_b32 v97, v99
  v_add_f32 v96, v96, v98
  v_add_f32 v97, v97, v99
  s_nop 1
  v_permlane16_swap_b32 v96, v97
  v_add_f32 v96, v96, v97
  s_nop 1
  v_add_f32_dpp v96, v96, v96 row_ror:8 row_mask:0xf bank_mask:0xf
  s_nop 1
  v_add_f32_dpp v96, v96, v96 row_ror:4 row_mask:0xf bank_mask:0xf
  v_cvt_pk_bf16_f32 v96, 0, v96
  v_mul_f32 v96, v92, v96
  v_cvt_pk_bf16_f32 v96, 0, v96
  v_add_f32 v96, v90, v96
  v_cvt_pk_bf16_f32 v96, v96, v96
  s_mov_b32 exec_lo, 0x000f000f
  s_mov_b32 exec_hi, 0x000f000f
  buffer_store_short v96, v94, s[44:47], 0 offen
L_endt:
  s_endpgm
L_ffn:
  v_lshl_add_u32 v117, v5, 2, v4
  v_lshlrev_b32 v117, 2, v117
  v_lshlrev_b32 v9, 11, v4
  v_lshl_add_u32 v9, v5, 4, v9
  s_lshl_b32 s62, s3, 8
  s_add_u32 s64, s62, 163840
  s_add_u32 s66, s62, 172032
  s_lshl_b32 s85, s60, 11
  s_add_u32 s85, s85, s62
  s_add_u32 s85, s85, 196608
  s_lshl_b32 s63, s3, 9
  s_add_u32 s63, s63, 16896
  v_lshlrev_b32 v118, 5, v1
  v_add_u32 v14, s63, v118
  s_lshl_b32 s63, s3, 4
  s_add_u32 s63, s63, 16128
  v_mov_b32 v121, 1.0
  v_lshrrev_b32 v119, 5, v1
  v_lshlrev_b32 v119, 2, v119
  v_add_u32 v119, s63, v119
  v_and_b32 v120, 7, v1
  v_lshlrev_b32 v120, 4, v120
  s_load_dword s93, s[4:5], 0
  v_and_b32 v118, 7, v1
  v_bfe_u32 v119, v1, 3, 1
  v_lshl_add_u32 v118, v118, 1, v119
  v_lshlrev_b32 v118, 4, v118
  s_lshr_b32 s62, s3, 1
  s_lshl_b32 s62, s62, 10
  s_and_b32 s63, s3, 1
  s_lshl_b32 s63, s63, 3
  s_add_u32 s62, s62, s63
  s_add_u32 s62, s62, 16896
  v_lshl_add_u32 v14, v4, 8, v118
  v_add_u32 v14, s62, v14
  s_lshl_b32 s63, s3, 3
  s_add_u32 s63, s63, 16128
  v_lshrrev_b32 v119, 5, v1
  v_lshlrev_b32 v119, 2, v119
  v_add_u32 v119, s63, v119
  v_and_b32 v120, 3, v1
  v_lshlrev_b32 v120, 4, v120
  v_mov_b32 v122, 0x3b000000
  s_mov_b32 s16, 0x10000
  s_mov_b32 s17, 0x10000
  s_waitcnt lgkmcnt(0)
  s_lshl_b32 s93, s93, 16
L_f_again:
  s_mov_b32 s73, 0x0c04000c
  s_mov_b32 s61, s97
  s_add_u32 s78, s64, 0
  s_add_u32 s79, s64, 8192
  s_add_u32 s80, s64, 16384
  s_add_u32 s81, s64, 24576
  s_mov_b64 s[6:7], -1
  s_mov_b64 s[8:9], -1
  s_mov_b64 s[10:11], -1
  s_mov_b64 s[12:13], -1
L_f_poll:
  s_and_b64 exec, s[6:7], s[6:7]
  s_cbranch_scc0 L_f_s0
  buffer_load_dwordx4 v[96:99], v9, s[40:43], s78 offen sc1
L_f_s0:
  s_and_b64 exec, s[8:9], s[8:9]
  s_cbranch_scc0 L_f_s1
  buffer_load_dwordx4 v[100:103], v9, s[40:43], s79 offen sc1
L_f_s1:
  s_and_b64 exec, s[10:11], s[10:11]
  s_cbranch_scc0 L_f_s2
  buffer_load_dwordx4 v[104:107], v9, s[40:43], s80 offen sc1
L_f_s2:
  s_and_b64 exec, s[12:13], s[12:13]
  s_cbranch_scc0 L_f_s3
  buffer_load_dwordx4 v[108:111], v9, s[40:43], s81 offen sc1
L_f_s3:
  s_mov_b64 exec, -1
  s_sub_u32 s61, s61, 1
  s_cbranch_scc1 L_f_ok
L_f_chk:
  s_waitcnt vmcnt(0)
  v_cmp_ne_u32 s[6:7], s67, v99
  v_cmp_ne_u32 s[8:9], s67, v103
  v_cmp_ne_u32 s[10:11], s67, v107
  v_cmp_ne_u32 s[12:13], s67, v111
  v_pk_add_f32 v[112:113], v[96:97], v[100:101]
  v_pk_add_f32 v[114:115], v[104:105], v[108:109]
  s_or_b64 s[14:15], s[6:7], s[8:9]
  s_or_b64 s[14:15], s[14:15], s[10:11]
  s_or_b64 s[14:15], s[14:15], s[12:13]
  s_cbranch_scc1 L_f_poll
L_f_ok:
  v_perm_b32 v99, v97, v96, s73
  v_perm_b32 v103, v101, v100, s73
  v_perm_b32 v107, v105, v104, s73
  v_perm_b32 v111, v109, v108, s73
  v_lshl_or_b32 v99, v98, 24, v99
  v_lshl_or_b32 v103, v102, 24, v103
  v_lshl_or_b32 v107, v106, 24, v107
  v_lshl_or_b32 v111, v110, 24, v111
  v_pk_add_f32 v[96:97], v[112:113], v[114:115]
  v_pk_add_f32 v[98:99], v[98:99], v[102:103]
  v_pk_add_f32 v[106:107], v[106:107], v[110:111]
  v_pk_add_f32 v[98:99], v[98:99], v[106:107]
  s_nop 1
  v_permlane32_swap_b32 v96, v98
  v_permlane32_swap_b32 v97, v99
  v_add_f32 v96, v96, v98
  v_add_f32 v97, v97, v99
  s_nop 1
  v_permlane16_swap_b32 v96, v97
  v_add_f32 v96, v96, v97
  v_cvt_pk_bf16_f32 v96, 0, v96
  v_mul_f32 v96, v91, v96
  v_cvt_pk_bf16_f32 v96, 0, v96
  v_add_f32 v96, v90, v96
  v_cvt_pk_bf16_f32 v96, 0, v96
  v_subrev_f32 v97, s93, v96
  v_mul_f32 v98, v97, v97
  s_nop 1
  v_permlane32_swap_b32 v97, v98
  v_add_f32 v97, v97, v98
  s_nop 1
  v_add_f32_dpp v97, v97, v97 row_ror:8 row_mask:0xf bank_mask:0xf
  s_nop 1
  v_add_f32_dpp v97, v97, v97 row_ror:4 row_mask:0xf bank_mask:0xf
  s_nop 1
  v_add_f32_dpp v97, v97, v97 row_ror:2 row_mask:0xf bank_mask:0xf
  s_nop 1
  v_add_f32_dpp v97, v97, v97 row_ror:1 row_mask:0xf bank_mask:0xf
  s_nop 1
  v_add_f32_dpp v97, v97, v97 row_bcast:15 row_mask:0xa bank_mask:0xf
  s_mov_b64 exec, s[16:17]
  ds_write_b32 v119, v97
  s_mov_b64 exec, -1
  s_waitcnt lgkmcnt(0)
  s_barrier
  ds_read_b128 v[100:103], v120 offset:16128
  s_waitcnt lgkmcnt(0)
  v_pk_add_f32 v[100:101], v[100:101], v[102:103]
  s_nop 1
  v_add_f32_dpp v100, v100, v100 quad_perm:[1,0,3,2] row_mask:0xf bank_mask:0xf
  v_add_f32_dpp v101, v101, v101 quad_perm:[1,0,3,2] row_mask:0xf bank_mask:0xf
  s_nop 0
  v_add_f32_dpp v100, v100, v100 quad_perm:[2,3,0,1] row_mask:0xf bank_mask:0xf
  v_add_f32_dpp v101, v101, v101 quad_perm:[2,3,0,1] row_mask:0xf bank_mask:0xf
  v_mul_f32 v100, v122, v100
  v_mul_f32 v101, v122, v101
  v_fma_f32 v101, -v100, v100, v101
  v_add_f32 v100, s93, v100
  v_max_f32 v101, 0, v101
  v_cvt_pk_bf16_f32 v100, 0, v100
  v_cvt_pk_bf16_f32 v101, 0, v101
  v_sub_f32 v96, v96, v100
  v_add_f32 v101, 0x3727c5ac, v101
  v_cvt_pk_bf16_f32 v101, 0, v101
  v_sqrt_f32 v101, v101
  v_cvt_pk_bf16_f32 v96, 0, v96
  v_cvt_pk_bf16_f32 v101, 0, v101
  v_rcp_f32 v102, v101
  s_nop 0
  v_mul_f32 v96, v96, v102
  v_cvt_pk_bf16_f32 v96, 0, v96
  v_mul_f32 v96, v96, v92
  v_cvt_pk_bf16_f32 v96, 0, v96
  v_add_f32 v96, v96, v93
  s_nop 1
  v_mov_b32_dpp v73, v96 row_shl:2 row_mask:0xf bank_mask:0xf
  v_cvt_pk_bf16_f32 v76, v96, v73
  s_nop 1
  v_mov_b32_dpp v72, v76 row_newbcast:0 row_mask:0xf bank_mask:0xf
  v_mov_b32_dpp v73, v76 row_newbcast:4 row_mask:0xf bank_mask:0xf
  v_mov_b32_dpp v74, v76 row_newbcast:8 row_mask:0xf bank_mask:0xf
  v_mov_b32_dpp v75, v76 row_newbcast:12 row_mask:0xf bank_mask:0xf
  s_nop 1
  v_mfma_f32_16x16x32_bf16 v[32:35], v[72:75], v[160:163], 0
  v_mov_b32_dpp v80, v76 row_newbcast:1 row_mask:0xf bank_mask:0xf
  v_mov_b32_dpp v81, v76 row_newbcast:5 row_mask:0xf bank_mask:0xf
  v_mfma_f32_16x16x32_bf16 v[36:39], v[72:75], v[164:167], 0
  v_mov_b32_dpp v82, v76 row_newbcast:9 row_mask:0xf bank_mask:0xf
  v_mov_b32_dpp v83, v76 row_newbcast:13 row_mask:0xf bank_mask:0xf
  v_mfma_f32_16x16x32_bf16 v[40:43], v[72:75], v[168:171], 0
  v_mfma_f32_16x16x32_bf16 v[44:47], v[72:75], v[172:175], 0
  v_mfma_f32_16x16x32_bf16 v[48:51], v[72:75], v[192:195], 0
  v_mfma_f32_16x16x32_bf16 v[52:55], v[72:75], v[196:199], 0
  v_mfma_f32_16x16x32_bf16 v[56:59], v[72:75], v[200:203], 0
  v_mfma_f32_16x16x32_bf16 v[60:63], v[72:75], v[204:207], 0
  v_mfma_f32_16x16x32_bf16 v[32:35], v[80:83], v[176:179], v[32:35]
  v_mfma_f32_16x16x32_bf16 v[36:39], v[80:83], v[180:183], v[36:39]
  v_mfma_f32_16x16x32_bf16 v[40:43], v[80:83], v[184:187], v[40:43]
  v_mfma_f32_16x16x32_bf16 v[44:47], v[80:83], v[188:191], v[44:47]
  v_mfma_f32_16x16x32_bf16 v[48:51], v[80:83], v[208:211], v[48:51]
  v_mfma_f32_16x16x32_bf16 v[52:55], v[80:83], v[212:215], v[52:55]
  v_mfma_f32_16x16x32_bf16 v[56:59], v[80:83], v[216:219], v[56:59]
  v_mfma_f32_16x16x32_bf16 v[60:63], v[80:83], v[220:223], v[60:63]
  s_nop 1
  v_mov_b32_dpp v32, v36 quad_perm:[0,1,2,3] row_mask:2 bank_mask:0xf
  s_nop 1
  v_mov_b32_dpp v32, v40 quad_perm:[0,1,2,3] row_mask:4 bank_mask:0xf
  s_nop 1
  v_mov_b32_dpp v32, v44 quad_perm:[0,1,2,3] row_mask:8 bank_mask:0xf
  v_mov_b32_dpp v48, v52 quad_perm:[0,1,2,3] row_mask:2 bank_mask:0xf
  s_nop 1
  v_mov_b32_dpp v48, v56 quad_perm:[0,1,2,3] row_mask:4 bank_mask:0xf
  s_nop 1
  v_mov_b32_dpp v48, v60 quad_perm:[0,1,2,3] row_mask:8 bank_mask:0xf
  ds_write2_b32 v14, v32, v48 offset0:0 offset1:1
  s_waitcnt lgkmcnt(0)
  s_barrier
  ds_read_b128 v[96:99], v3 offset:16896
  ds_read_b128 v[100:103], v3 offset:17920
  ds_read_b128 v[104:107], v3 offset:18944
  ds_read_b128 v[108:111], v3 offset:19968
  s_waitcnt lgkmcnt(2)
  v_pk_add_f32 v[96:97], v[96:97], v[100:101]
  v_pk_add_f32 v[98:99], v[98:99], v[102:103]
  s_waitcnt lgkmcnt(0)
  v_pk_add_f32 v[104:105], v[104:105], v[108:109]
  v_pk_add_f32 v[106:107], v[106:107], v[110:111]
  v_pk_add_f32 v[96:97], v[96:97], v[104:105]
  v_pk_add_f32 v[98:99], v[98:99], v[106:107]
  v_pk_add_f32 v[96:97], v[96:97], v[98:99]
  v_cvt_pk_bf16_f32 v96, 0, v96
  v_mul_f32 v99, v96, v96
  v_fmamk_f32 v99, v99, 0x3d372713, v121
  v_mul_f32 v99, v99, v96
  v_mul_f32 v99, 0xc0135761, v99
  v_exp_f32 v99, v99
  v_cvt_pk_bf16_f32 v97, 0, v97
  v_add_f32 v99, 1.0, v99
  v_rcp_f32 v99, v99
  s_nop 0
  v_mul_f32 v99, v96, v99
  v_cvt_pk_bf16_f32 v99, 0, v99
  v_mul_f32 v99, v99, v97
  s_nop 1
  v_mov_b32_dpp v73, v99 row_shl:2 row_mask:0xf bank_mask:0xf
  v_cvt_pk_bf16_f32 v76, v99, v73
  s_nop 1
  v_mov_b32_dpp v72, v76 row_newbcast:0 row_mask:0xf bank_mask:0xf
  v_mov_b32_dpp v73, v76 row_newbcast:4 row_mask:0xf bank_mask:0xf
  v_mov_b32_dpp v74, v76 row_newbcast:8 row_mask:0xf bank_mask:0xf
  v_mov_b32_dpp v75, v76 row_newbcast:12 row_mask:0xf bank_mask:0xf
  s_nop 1
  v_mfma_f32_16x16x32_bf16 v[32:35], v[72:75], v[224:227], 0
  v_mov_b32_dpp v80, v76 row_newbcast:1 row_mask:0xf bank_mask:0xf
  v_mov_b32_dpp v81, v76 row_newbcast:5 row_mask:0xf bank_mask:0xf
  v_mfma_f32_16x16x32_bf16 v[36:39], v[72:75], v[228:231], 0
  v_mov_b32_dpp v82, v76 row_newbcast:9 row_mask:0xf bank_mask:0xf
  v_mov_b32_dpp v83, v76 row_newbcast:13 row_mask:0xf bank_mask:0xf
  v_mfma_f32_16x16x32_bf16 v[40:43], v[72:75], v[232:235], 0
  v_mfma_f32_16x16x32_bf16 v[44:47], v[72:75], v[236:239], 0
  v_mfma_f32_16x16x32_bf16 v[32:35], v[80:83], v[240:243], v[32:35]
  v_mfma_f32_16x16x32_bf16 v[36:39], v[80:83], v[244:247], v[36:39]
  v_mfma_f32_16x16x32_bf16 v[40:43], v[80:83], v[248:251], v[40:43]
  v_mfma_f32_16x16x32_bf16 v[44:47], v[80:83], v[252:255], v[44:47]
  s_mov_b64 exec, 0xffff
  s_nop 3
  v_bfi_b32 v64, v15, s67, v32
  v_bfi_b32 v65, v15, s68, v36
  v_bfi_b32 v66, v15, s69, v40
  v_bfi_b32 v67, v15, s70, v44
  buffer_store_dwordx4 v[64:67], v118, s[40:43], s85 offen sc1
L_end:
  s_endpgm
L_lsp2:
  s_cmp_lt_u32 s77, 3
  s_cbranch_scc1 L_ld
  s_mov_b32 s87, 0
  v_bfe_u32 v24, v1, 3, 1
  v_lshl_add_u32 v24, v24, 2, v4
  v_and_b32 v27, 7, v1
  v_lshlrev_b32 v27, 4, v27
  v_lshl_add_u32 v25, v24, 10, v27
  s_cmp_eq_u32 s72, 4
  s_cbranch_scc1 L_w1l_ffn
  s_mov_b32 s44, s12
  s_mov_b32 s45, s13
  s_mov_b32 s46, 4194304
  s_lshl_b32 s63, s58, 19
  s_lshl_b32 s64, s3, 15
  s_add_u32 s63, s63, s64
  s_lshr_b32 s64, s60, 2
  s_lshl_b32 s64, s64, 18
  s_add_u32 s63, s63, s64
  s_and_b32 s64, s60, 3
  s_lshl_b32 s64, s64, 8
  s_add_u32 s63, s63, s64
  s_mov_b32 s66, 4096
  v_lshlrev_b32 v25, 4, v5
  v_lshl_add_u32 v25, v4, 10, v25
  s_nop 0
  s_branch L_w1l_d
L_w1l_ffn:
  v_mul_u32_u24 v26, 3584, v24
  v_add_u32 v26, v26, v27
  s_mov_b32 s46, 1835008
  s_mul_i32 s65, s3, 229376
  s_lshl_b32 s64, s60, 7
  s_add_u32 s65, s65, s64
  s_mov_b32 s44, s16
  s_mov_b32 s45, s17
  s_mov_b32 s63, s65
  buffer_load_dwordx4 v[128:131], v26, s[44:47], s63 offen nt
  s_add_u32 s63, s63, 28672
  s_waitcnt vmcnt(21)
  buffer_load_dwordx4 v[132:135], v26, s[44:47], s63 offen nt
  s_add_u32 s63, s63, 28672
  s_waitcnt vmcnt(21)
  buffer_load_dwordx4 v[136:139], v26, s[44:47], s63 offen nt
  s_add_u32 s63, s63, 28672
  s_waitcnt vmcnt(21)
  buffer_load_dwordx4 v[140:143], v26, s[44:47], s63 offen nt
  s_add_u32 s63, s63, 28672
  s_waitcnt vmcnt(21)
  buffer_load_dwordx4 v[144:147], v26, s[44:47], s63 offen nt
  s_add_u32 s63, s63, 28672
  s_waitcnt vmcnt(21)
  buffer_load_dwordx4 v[148:151], v26, s[44:47], s63 offen nt
  s_add_u32 s63, s63, 28672
  s_waitcnt vmcnt(21)
  buffer_load_dwordx4 v[152:155], v26, s[44:47], s63 offen nt
  s_add_u32 s63, s63, 28672
  s_waitcnt vmcnt(21)
  buffer_load_dwordx4 v[156:159], v26, s[44:47], s63 offen nt
  s_waitcnt vmcnt(21)
  s_mov_b32 s44, s18
  s_mov_b32 s45, s19
  s_mov_b32 s63, s65
  buffer_load_dwordx4 v[160:163], v26, s[44:47], s63 offen nt
  s_add_u32 s63, s63, 28672
  s_waitcnt vmcnt(21)
  buffer_load_dwordx4 v[164:167], v26, s[44:47], s63 offen nt
  s_add_u32 s63, s63, 28672
  s_waitcnt vmcnt(21)
  buffer_load_dwordx4 v[168:171], v26, s[44:47], s63 offen nt
  s_add_u32 s63, s63, 28672
  s_waitcnt vmcnt(21)
  buffer_load_dwordx4 v[172:175], v26, s[44:47], s63 offen nt
  s_add_u32 s63, s63, 28672
  s_waitcnt vmcnt(21)
  buffer_load_dwordx4 v[176:179], v26, s[44:47], s63 offen nt
  s_add_u32 s63, s63, 28672
  s_waitcnt vmcnt(21)
  buffer_load_dwordx4 v[180:183], v26, s[44:47], s63 offen nt
  s_add_u32 s63, s63, 28672
  s_waitcnt vmcnt(21)
  buffer_load_dwordx4 v[184:187], v26, s[44:47], s63 offen nt
  s_add_u32 s63, s63, 28672
  s_waitcnt vmcnt(21)
  buffer_load_dwordx4 v[188:191], v26, s[44:47], s63 offen nt
  s_waitcnt vmcnt(21)
  s_mov_b32 s44, s20
  s_mov_b32 s45, s21
  s_lshl_b32 s63, s60, 16
  s_lshl_b32 s64, s3, 7
  s_add_u32 s63, s63, s64
  s_mov_b32 s66, 8192
L_w1l_d:
  buffer_load_dwordx4 v[192:195], v25, s[44:47], s63 offen nt
  s_add_u32 s63, s63, s66
  s_waitcnt vmcnt(21)
  buffer_load_dwordx4 v[196:199], v25, s[44:47], s63 offen nt
  s_add_u32 s63, s63, s66
  s_waitcnt vmcnt(21)
  buffer_load_dwordx4 v[200:203], v25, s[44:47], s63 offen nt
  s_add_u32 s63, s63, s66
  s_waitcnt vmcnt(21)
  buffer_load_dwordx4 v[204:207], v25, s[44:47], s63 offen nt
  s_add_u32 s63, s63, s66
  s_waitcnt vmcnt(21)
  buffer_load_dwordx4 v[208:211], v25, s[44:47], s63 offen nt
  s_add_u32 s63, s63, s66
  s_waitcnt vmcnt(21)
  buffer_load_dwordx4 v[212:215], v25, s[44:47], s63 offen nt
  s_add_u32 s63, s63, s66
  s_waitcnt vmcnt(21)
  buffer_load_dwordx4 v[216:219], v25, s[44:47], s63 offen nt
  s_add_u32 s63, s63, s66
  s_waitcnt vmcnt(21)
  buffer_load_dwordx4 v[220:223], v25, s[44:47], s63 offen nt
  s_waitcnt vmcnt(21)
L_w1l_e:
  s_branch L_ld
L_tree:
  s_cmp_ge_u32 s83, 6
  s_cbranch_scc1 L_lv6_10
  s_cmp_ge_u32 s83, 2
  s_cbranch_scc1 L_lv2_5
  s_cmp_ge_u32 s83, 1
  s_cbranch_scc1 L_lv1_1
  s_add_u32 m0, s76, 0
  s_add_u32 s55, s54, 0
  buffer_load_dwordx4 v22, s[32:35], s55 offen nt lds
  s_add_u32 s62, s79, -2
  s_max_i32 s81, s81, s62
  v_mov_b32 v10, s81
  s_waitcnt vmcnt(17)
  ds_write_b32 v9, v10 offset:15616
  s_add_u32 m0, s76, 1056
  s_add_u32 s55, s54, 1024
  buffer_load_dwordx4 v22, s[32:35], s55 offen nt lds
  s_waitcnt vmcnt(17)
  s_add_u32 m0, s76, 2112
  s_add_u32 s55, s54, 2048
  buffer_load_dwordx4 v22, s[32:35], s55 offen nt lds
  s_waitcnt vmcnt(17)
  s_add_u32 m0, s76, 3168
  s_add_u32 s55, s54, 3072
  buffer_load_dwordx4 v22, s[32:35], s55 offen nt lds
  s_waitcnt vmcnt(17)
  s_add_u32 m0, s76, 4224
  s_add_u32 s55, s54, 4096
  buffer_load_dwordx4 v22, s[32:35], s55 offen nt lds
  s_waitcnt vmcnt(17)
  s_add_u32 m0, s76, 5280
  s_add_u32 s55, s54, 5120
  buffer_load_dwordx4 v22, s[32:35], s55 offen nt lds
  s_waitcnt vmcnt(17)
  s_add_u32 m0, s76, 6336
  s_add_u32 s55, s54, 6144
  buffer_load_dwordx4 v22, s[32:35], s55 offen nt lds
  s_waitcnt vmcnt(17)
  s_add_u32 m0, s76, 7392
  s_add_u32 s55, s54, 7168
  buffer_load_dwordx4 v22, s[32:35], s55 offen nt lds
  s_waitcnt vmcnt(17)
  s_add_u32 m0, s85, 8448
  s_add_u32 s55, s84, 0
  buffer_load_dwordx4 v22, s[36:39], s55 offen nt lds
  s_add_u32 s62, s79, -1
  s_max_i32 s81, s81, s62
  v_mov_b32 v10, s81
  s_waitcnt vmcnt(17)
  ds_write_b32 v9, v10 offset:15616
  s_add_u32 m0, s85, 9504
  s_add_u32 s55, s84, 1024
  buffer_load_dwordx4 v22, s[36:39], s55 offen nt lds
  s_waitcnt vmcnt(17)
  s_add_u32 m0, s85, 10560
  s_add_u32 s55, s84, 2048
  s_add_u32 s80, s76, 16896
  v_add_u32 v14, 4, v14
  v_add_u32 v13, 4, v13
  s_cmp_eq_u32 s80, 157696
  s_cselect_b32 s80, 22528, s80
  v_and_b32 v14, 15967, v14
  buffer_load_dwordx4 v22, s[36:39], s55 offen nt lds
  s_waitcnt vmcnt(17)
  s_add_u32 m0, s85, 11616
  s_add_u32 s55, s84, 3072
  buffer_load_dwordx4 v22, s[36:39], s55 offen nt lds
  s_waitcnt vmcnt(17)
  s_add_u32 m0, s85, 12672
  s_add_u32 s55, s84, 4096
  buffer_load_dwordx4 v22, s[36:39], s55 offen nt lds
  s_waitcnt vmcnt(17)
  s_add_u32 m0, s85, 13728
  s_add_u32 s55, s84, 5120
  buffer_load_dwordx4 v22, s[36:39], s55 offen nt lds
  s_waitcnt vmcnt(17)
  s_add_u32 m0, s85, 14784
  s_add_u32 s55, s84, 6144
  buffer_load_dwordx4 v22, s[36:39], s55 offen nt lds
  s_waitcnt vmcnt(17)
  s_add_u32 m0, s85, 15840
  s_add_u32 s55, s84, 7168
  buffer_load_dwordx4 v22, s[36:39], s55 offen nt lds
  ds_read_b32 v11, v14
  ds_read_b32 v12, v13
  ds_read_b32 v17, v18 offset:4
  s_waitcnt vmcnt(17)
  s_mov_b32 s84, s86
  s_mov_b32 s85, s89
  s_mov_b32 s86, s54
  s_mov_b32 s89, s76
  s_mov_b32 s76, s80
  s_add_u32 s77, s77, 1
  s_add_u32 s78, s78, 1
  s_cmp_eq_u32 s87, 0
  s_cbranch_scc1 L_ld
  s_branch L_lsp
L_lv1_1:
  s_add_u32 m0, s76, 0
  s_add_u32 s55, s54, 0
  buffer_load_dwordx4 v22, s[32:35], s55 offen nt lds
  s_waitcnt vmcnt(18)
  s_add_u32 m0, s76, 1056
  s_add_u32 s55, s54, 1024
  buffer_load_dwordx4 v22, s[32:35], s55 offen nt lds
  s_add_u32 s62, s79, -2
  s_max_i32 s81, s81, s62
  v_mov_b32 v10, s81
  s_waitcnt vmcnt(18)
  ds_write_b32 v9, v10 offset:15616
  s_add_u32 m0, s76, 2112
  s_add_u32 s55, s54, 2048
  buffer_load_dwordx4 v22, s[32:35], s55 offen nt lds
  s_waitcnt vmcnt(18)
  s_add_u32 m0, s76, 3168
  s_add_u32 s55, s54, 3072
  buffer_load_dwordx4 v22, s[32:35], s55 offen nt lds
  s_waitcnt vmcnt(18)
  s_add_u32 m0, s76, 4224
  s_add_u32 s55, s54, 4096
  buffer_load_dwordx4 v22, s[32:35], s55 offen nt lds
  s_waitcnt vmcnt(18)
  s_add_u32 m0, s76, 5280
  s_add_u32 s55, s54, 5120
  buffer_load_dwordx4 v22, s[32:35], s55 offen nt lds
  s_waitcnt vmcnt(18)
  s_add_u32 m0, s76, 6336
  s_add_u32 s55, s54, 6144
  buffer_load_dwordx4 v22, s[32:35], s55 offen nt lds
  s_waitcnt vmcnt(18)
  s_add_u32 m0, s76, 7392
  s_add_u32 s55, s54, 7168
  buffer_load_dwordx4 v22, s[32:35], s55 offen nt lds
  s_waitcnt vmcnt(18)
  s_add_u32 m0, s85, 8448
  s_add_u32 s55, s84, 0
  buffer_load_dwordx4 v22, s[36:39], s55 offen nt lds
  s_waitcnt vmcnt(18)
  s_add_u32 m0, s85, 9504
  s_add_u32 s55, s84, 1024
  buffer_load_dwordx4 v22, s[36:39], s55 offen nt lds
  s_add_u32 s62, s79, -1
  s_max_i32 s81, s81, s62
  v_mov_b32 v10, s81
  s_waitcnt vmcnt(18)
  ds_write_b32 v9, v10 offset:15616
  s_add_u32 m0, s85, 10560
  s_add_u32 s55, s84, 2048
  s_add_u32 s80, s76, 16896
  v_add_u32 v14, 4, v14
  v_add_u32 v13, 4, v13
  s_cmp_eq_u32 s80, 157696
  s_cselect_b32 s80, 22528, s80
  v_and_b32 v14, 15967, v14
  buffer_load_dwordx4 v22, s[36:39], s55 offen nt lds
  s_waitcnt vmcnt(18)
  s_add_u32 m0, s85, 11616
  s_add_u32 s55, s84, 3072
  buffer_load_dwordx4 v22, s[36:39], s55 offen nt lds
  s_waitcnt vmcnt(18)
  s_add_u32 m0, s85, 12672
  s_add_u32 s55, s84, 4096
  buffer_load_dwordx4 v22, s[36:39], s55 offen nt lds
  s_waitcnt vmcnt(18)
  s_add_u32 m0, s85, 13728
  s_add_u32 s55, s84, 5120
  buffer_load_dwordx4 v22, s[36:39], s55 offen nt lds
  s_waitcnt vmcnt(18)
  s_add_u32 m0, s85, 14784
  s_add_u32 s55, s84, 6144
  buffer_load_dwordx4 v22, s[36:39], s55 offen nt lds
  s_waitcnt vmcnt(18)
  s_add_u32 m0, s85, 15840
  s_add_u32 s55, s84, 7168
  buffer_load_dwordx4 v22, s[36:39], s55 offen nt lds
  ds_read_b32 v11, v14
  ds_read_b32 v12, v13
  ds_read_b32 v17, v18 offset:4
  s_waitcnt vmcnt(18)
  s_mov_b32 s84, s86
  s_mov_b32 s85, s89
  s_mov_b32 s86, s54
  s_mov_b32 s89, s76
  s_mov_b32 s76, s80
  s_add_u32 s77, s77, 1
  s_add_u32 s78, s78, 1
  s_cmp_eq_u32 s87, 0
  s_cbranch_scc1 L_ld
  s_branch L_lsp
L_lv2_5:
  s_cmp_ge_u32 s83, 3
  s_cbranch_scc1 L_lv3_5
  s_add_u32 m0, s76, 0
  s_add_u32 s55, s54, 0
  buffer_load_dwordx4 v22, s[32:35], s55 offen nt lds
  s_waitcnt vmcnt(19)
  s_add_u32 m0, s76, 1056
  s_add_u32 s55, s54, 1024
  buffer_load_dwordx4 v22, s[32:35], s55 offen nt lds
  s_waitcnt vmcnt(19)
  s_add_u32 m0, s76, 2112
  s_add_u32 s55, s54, 2048
  buffer_load_dwordx4 v22, s[32:35], s55 offen nt lds
  s_add_u32 s62, s79, -2
  s_max_i32 s81, s81, s62
  v_mov_b32 v10, s81
  s_waitcnt vmcnt(19)
  ds_write_b32 v9, v10 offset:15616
  s_add_u32 m0, s76, 3168
  s_add_u32 s55, s54, 3072
  buffer_load_dwordx4 v22, s[32:35], s55 offen nt lds
  s_waitcnt vmcnt(19)
  s_add_u32 m0, s76, 4224
  s_add_u32 s55, s54, 4096
  buffer_load_dwordx4 v22, s[32:35], s55 offen nt lds
  s_waitcnt vmcnt(19)
  s_add_u32 m0, s76, 5280
  s_add_u32 s55, s54, 5120
  buffer_load_dwordx4 v22, s[32:35], s55 offen nt lds
  s_waitcnt vmcnt(19)
  s_add_u32 m0, s76, 6336
  s_add_u32 s55, s54, 6144
  buffer_load_dwordx4 v22, s[32:35], s55 offen nt lds
  s_waitcnt vmcnt(19)
  s_add_u32 m0, s76, 7392
  s_add_u32 s55, s54, 7168
  buffer_load_dwordx4 v22, s[32:35], s55 offen nt lds
  s_waitcnt vmcnt(19)
  s_add_u32 m0, s85, 8448
  s_add_u32 s55, s84, 0
  buffer_load_dwordx4 v22, s[36:39], s55 offen nt lds
  s_waitcnt vmcnt(19)
  s_add_u32 m0, s85, 9504
  s_add_u32 s55, s84, 1024
  buffer_load_dwordx4 v22, s[36:39], s55 offen nt lds
  s_waitcnt vmcnt(19)
  s_add_u32 m0, s85, 10560
  s_add_u32 s55, s84, 2048
  s_add_u32 s80, s76, 16896
  v_add_u32 v14, 4, v14
  v_add_u32 v13, 4, v13
  s_cmp_eq_u32 s80, 157696
  s_cselect_b32 s80, 22528, s80
  v_and_b32 v14, 15967, v14
  buffer_load_dwordx4 v22, s[36:39], s55 offen nt lds
  s_add_u32 s62, s79, -1
  s_max_i32 s81, s81, s62
  v_mov_b32 v10, s81
  s_waitcnt vmcnt(19)
  ds_write_b32 v9, v10 offset:15616
  s_add_u32 m0, s85, 11616
  s_add_u32 s55, s84, 3072
  buffer_load_dwordx4 v22, s[36:39], s55 offen nt lds
  s_waitcnt vmcnt(19)
  s_add_u32 m0, s85, 12672
  s_add_u32 s55, s84, 4096
  buffer_load_dwordx4 v22, s[36:39], s55 offen nt lds
  s_waitcnt vmcnt(19)
  s_add_u32 m0, s85, 13728
  s_add_u32 s55, s84, 5120
  buffer_load_dwordx4 v22, s[36:39], s55 offen nt lds
  s_waitcnt vmcnt(19)
  s_add_u32 m0, s85, 14784
  s_add_u32 s55, s84, 6144
  buffer_load_dwordx4 v22, s[36:39], s55 offen nt lds
  s_waitcnt vmcnt(19)
  s_add_u32 m0, s85, 15840
  s_add_u32 s55, s84, 7168
  buffer_load_dwordx4 v22, s[36:39], s55 offen nt lds
  ds_read_b32 v11, v14
  ds_read_b32 v12, v13
  ds_read_b32 v17, v18 offset:4
  s_waitcnt vmcnt(19)
  s_mov_b32 s84, s86
  s_mov_b32 s85, s89
  s_mov_b32 s86, s54
  s_mov_b32 s89, s76
  s_mov_b32 s76, s80
  s_add_u32 s77, s77, 1
  s_add_u32 s78, s78, 1
  s_cmp_eq_u32 s87, 0
  s_cbranch_scc1 L_ld
  s_branch L_lsp
L_lv3_5:
  s_cmp_ge_u32 s83, 5
  s_cbranch_scc1 L_lv5_5
  s_add_u32 m0, s76, 0
  s_add_u32 s55, s54, 0
  buffer_load_dwordx4 v22, s[32:35], s55 offen nt lds
  s_waitcnt vmcnt(20)
  s_add_u32 m0, s76, 1056
  s_add_u32 s55, s54, 1024
  buffer_load_dwordx4 v22, s[32:35], s55 offen nt lds
  s_waitcnt vmcnt(20)
  s_add_u32 m0, s76, 2112
  s_add_u32 s55, s54, 2048
  buffer_load_dwordx4 v22, s[32:35], s55 offen nt lds
  s_waitcnt vmcnt(20)
  s_add_u32 m0, s76, 3168
  s_add_u32 s55, s54, 3072
  buffer_load_dwordx4 v22, s[32:35], s55 offen nt lds
  s_add_u32 s62, s79, -2
  s_max_i32 s81, s81, s62
  v_mov_b32 v10, s81
  s_waitcnt vmcnt(20)
  ds_write_b32 v9, v10 offset:15616
  s_add_u32 m0, s76, 4224
  s_add_u32 s55, s54, 4096
  buffer_load_dwordx4 v22, s[32:35], s55 offen nt lds
  s_waitcnt vmcnt(20)
  s_add_u32 m0, s76, 5280
  s_add_u32 s55, s54, 5120
  buffer_load_dwordx4 v22, s[32:35], s55 offen nt lds
  s_waitcnt vmcnt(20)
  s_add_u32 m0, s76, 6336
  s_add_u32 s55, s54, 6144
  buffer_load_dwordx4 v22, s[32:35], s55 offen nt lds
  s_waitcnt vmcnt(20)
  s_add_u32 m0, s76, 7392
  s_add_u32 s55, s54, 7168
  buffer_load_dwordx4 v22, s[32:35], s55 offen nt lds
  s_waitcnt vmcnt(20)
  s_add_u32 m0, s85, 8448
  s_add_u32 s55, s84, 0
  buffer_load_dwordx4 v22, s[36:39], s55 offen nt lds
  s_waitcnt vmcnt(20)
  s_add_u32 m0, s85, 9504
  s_add_u32 s55, s84, 1024
  buffer_load_dwordx4 v22, s[36:39], s55 offen nt lds
  s_waitcnt vmcnt(20)
  s_add_u32 m0, s85, 10560
  s_add_u32 s55, s84, 2048
  s_add_u32 s80, s76, 16896
  v_add_u32 v14, 4, v14
  v_add_u32 v13, 4, v13
  s_cmp_eq_u32 s80, 157696
  s_cselect_b32 s80, 22528, s80
  v_and_b32 v14, 15967, v14
  buffer_load_dwordx4 v22, s[36:39], s55 offen nt lds
  s_waitcnt vmcnt(20)
  s_add_u32 m0, s85, 11616
  s_add_u32 s55, s84, 3072
  buffer_load_dwordx4 v22, s[36:39], s55 offen nt lds
  s_add_u32 s62, s79, -1
  s_max_i32 s81, s81, s62
  v_mov_b32 v10, s81
  s_waitcnt vmcnt(20)
  ds_write_b32 v9, v10 offset:15616
  s_add_u32 m0, s85, 12672
  s_add_u32 s55, s84, 4096
  buffer_load_dwordx4 v22, s[36:39], s55 offen nt lds
  s_waitcnt vmcnt(20)
  s_add_u32 m0, s85, 13728
  s_add_u32 s55, s84, 5120
  buffer_load_dwordx4 v22, s[36:39], s55 offen nt lds
  s_waitcnt vmcnt(20)
  s_add_u32 m0, s85, 14784
  s_add_u32 s55, s84, 6144
  buffer_load_dwordx4 v22, s[36:39], s55 offen nt lds
  s_waitcnt vmcnt(20)
  s_add_u32 m0, s85, 15840
  s_add_u32 s55, s84, 7168
  buffer_load_dwordx4 v22, s[36:39], s55 offen nt lds
  ds_read_b32 v11, v14
  ds_read_b32 v12, v13
  ds_read_b32 v17, v18 offset:4
  s_waitcnt vmcnt(20)
  s_mov_b32 s84, s86
  s_mov_b32 s85, s89
  s_mov_b32 s86, s54
  s_mov_b32 s89, s76
  s_mov_b32 s76, s80
  s_add_u32 s77, s77, 1
  s_add_u32 s78, s78, 1
  s_cmp_eq_u32 s87, 0
  s_cbranch_scc1 L_ld
  s_branch L_lsp
L_lv5_5:
  s_add_u32 m0, s76, 0
  s_add_u32 s55, s54, 0
  buffer_load_dwordx4 v22, s[32:35], s55 offen nt lds
  s_waitcnt vmcnt(22)
  s_add_u32 m0, s76, 1056
  s_add_u32 s55, s54, 1024
  buffer_load_dwordx4 v22, s[32:35], s55 offen nt lds
  s_waitcnt vmcnt(22)
  s_add_u32 m0, s76, 2112
  s_add_u32 s55, s54, 2048
  buffer_load_dwordx4 v22, s[32:35], s55 offen nt lds
  s_waitcnt vmcnt(22)
  s_add_u32 m0, s76, 3168
  s_add_u32 s55, s54, 3072
  buffer_load_dwordx4 v22, s[32:35], s55 offen nt lds
  s_waitcnt vmcnt(22)
  s_add_u32 m0, s76, 4224
  s_add_u32 s55, s54, 4096
  buffer_load_dwordx4 v22, s[32:35], s55 offen nt lds
  s_waitcnt vmcnt(22)
  s_add_u32 m0, s76, 5280
  s_add_u32 s55, s54, 5120
  buffer_load_dwordx4 v22, s[32:35], s55 offen nt lds
  s_add_u32 s62, s79, -2
  s_max_i32 s81, s81, s62
  v_mov_b32 v10, s81
  s_waitcnt vmcnt(22)
  ds_write_b32 v9, v10 offset:15616
  s_add_u32 m0, s76, 6336
  s_add_u32 s55, s54, 6144
  buffer_load_dwordx4 v22, s[32:35], s55 offen nt lds
  s_waitcnt vmcnt(22)
  s_add_u32 m0, s76, 7392
  s_add_u32 s55, s54, 7168
  buffer_load_dwordx4 v22, s[32:35], s55 offen nt lds
  s_waitcnt vmcnt(22)
  s_add_u32 m0, s85, 8448
  s_add_u32 s55, s84, 0
  buffer_load_dwordx4 v22, s[36:39], s55 offen nt lds
  s_waitcnt vmcnt(22)
  s_add_u32 m0, s85, 9504
  s_add_u32 s55, s84, 1024
  buffer_load_dwordx4 v22, s[36:39], s55 offen nt lds
  s_waitcnt vmcnt(22)
  s_add_u32 m0, s85, 10560
  s_add_u32 s55, s84, 2048
  s_add_u32 s80, s76, 16896
  v_add_u32 v14, 4, v14
  v_add_u32 v13, 4, v13
  s_cmp_eq_u32 s80, 157696
  s_cselect_b32 s80, 22528, s80
  v_and_b32 v14, 15967, v14
  buffer_load_dwordx4 v22, s[36:39], s55 offen nt lds
  s_waitcnt vmcnt(22)
  s_add_u32 m0, s85, 11616
  s_add_u32 s55, s84, 3072
  buffer_load_dwordx4 v22, s[36:39], s55 offen nt lds
  s_waitcnt vmcnt(22)
  s_add_u32 m0, s85, 12672
  s_add_u32 s55, s84, 4096
  buffer_load_dwordx4 v22, s[36:39], s55 offen nt lds
  s_waitcnt vmcnt(22)
  s_add_u32 m0, s85, 13728
  s_add_u32 s55, s84, 5120
  buffer_load_dwordx4 v22, s[36:39], s55 offen nt lds
  s_add_u32 s62, s79, -1
  s_max_i32 s81, s81, s62
  v_mov_b32 v10, s81
  s_waitcnt vmcnt(22)
  ds_write_b32 v9, v10 offset:15616
  s_add_u32 m0, s85, 14784
  s_add_u32 s55, s84, 6144
  buffer_load_dwordx4 v22, s[36:39], s55 offen nt lds
  s_waitcnt vmcnt(22)
  s_add_u32 m0, s85, 15840
  s_add_u32 s55, s84, 7168
  buffer_load_dwordx4 v22, s[36:39], s55 offen nt lds
  ds_read_b32 v11, v14
  ds_read_b32 v12, v13
  ds_read_b32 v17, v18 offset:4
  s_waitcnt vmcnt(22)
  s_mov_b32 s84, s86
  s_mov_b32 s85, s89
  s_mov_b32 s86, s54
  s_mov_b32 s89, s76
  s_mov_b32 s76, s80
  s_add_u32 s77, s77, 1
  s_add_u32 s78, s78, 1
  s_cmp_eq_u32 s87, 0
  s_cbranch_scc1 L_ld
  s_branch L_lsp
L_lv6_10:
  s_cmp_ge_u32 s83, 8
  s_cbranch_scc1 L_lv8_10
  s_cmp_ge_u32 s83, 7
  s_cbranch_scc1 L_lv7_7
  s_add_u32 m0, s76, 0
  s_add_u32 s55, s54, 0
  buffer_load_dwordx4 v22, s[32:35], s55 offen nt lds
  s_waitcnt vmcnt(23)
  s_add_u32 m0, s76, 1056
  s_add_u32 s55, s54, 1024
  buffer_load_dwordx4 v22, s[32:35], s55 offen nt lds
  s_waitcnt vmcnt(23)
  s_add_u32 m0, s76, 2112
  s_add_u32 s55, s54, 2048
  buffer_load_dwordx4 v22, s[32:35], s55 offen nt lds
  s_waitcnt vmcnt(23)
  s_add_u32 m0, s76, 3168
  s_add_u32 s55, s54, 3072
  buffer_load_dwordx4 v22, s[32:35], s55 offen nt lds
  s_waitcnt vmcnt(23)
  s_add_u32 m0, s76, 4224
  s_add_u32 s55, s54, 4096
  buffer_load_dwordx4 v22, s[32:35], s55 offen nt lds
  s_waitcnt vmcnt(23)
  s_add_u32 m0, s76, 5280
  s_add_u32 s55, s54, 5120
  buffer_load_dwordx4 v22, s[32:35], s55 offen nt lds
  s_waitcnt vmcnt(23)
  s_add_u32 m0, s76, 6336
  s_add_u32 s55, s54, 6144
  buffer_load_dwordx4 v22, s[32:35], s55 offen nt lds
  s_add_u32 s62, s79, -2
  s_max_i32 s81, s81, s62
  v_mov_b32 v10, s81
  s_waitcnt vmcnt(23)
  ds_write_b32 v9, v10 offset:15616
  s_add_u32 m0, s76, 7392
  s_add_u32 s55, s54, 7168
  buffer_load_dwordx4 v22, s[32:35], s55 offen nt lds
  s_waitcnt vmcnt(23)
  s_add_u32 m0, s85, 8448
  s_add_u32 s55, s84, 0
  buffer_load_dwordx4 v22, s[36:39], s55 offen nt lds
  s_waitcnt vmcnt(23)
  s_add_u32 m0, s85, 9504
  s_add_u32 s55, s84, 1024
  buffer_load_dwordx4 v22, s[36:39], s55 offen nt lds
  s_waitcnt vmcnt(23)
  s_add_u32 m0, s85, 10560
  s_add_u32 s55, s84, 2048
  s_add_u32 s80, s76, 16896
  v_add_u32 v14, 4, v14
  v_add_u32 v13, 4, v13
  s_cmp_eq_u32 s80, 157696
  s_cselect_b32 s80, 22528, s80
  v_and_b32 v14, 15967, v14
  buffer_load_dwordx4 v22, s[36:39], s55 offen nt lds
  s_waitcnt vmcnt(23)
  s_add_u32 m0, s85, 11616
  s_add_u32 s55, s84, 3072
  buffer_load_dwordx4 v22, s[36:39], s55 offen nt lds
  s_waitcnt vmcnt(23)
  s_add_u32 m0, s85, 12672
  s_add_u32 s55, s84, 4096
  buffer_load_dwordx4 v22, s[36:39], s55 offen nt lds
  s_waitcnt vmcnt(23)
  s_add_u32 m0, s85, 13728
  s_add_u32 s55, s84, 5120
  buffer_load_dwordx4 v22, s[36:39], s55 offen nt lds
  s_waitcnt vmcnt(23)
  s_add_u32 m0, s85, 14784
  s_add_u32 s55, s84, 6144
  buffer_load_dwordx4 v22, s[36:39], s55 offen nt lds
  s_add_u32 s62, s79, -1
  s_max_i32 s81, s81, s62
  v_mov_b32 v10, s81
  s_waitcnt vmcnt(23)
  ds_write_b32 v9, v10 offset:15616
  s_add_u32 m0, s85, 15840
  s_add_u32 s55, s84, 7168
  buffer_load_dwordx4 v22, s[36:39], s55 offen nt lds
  ds_read_b32 v11, v14
  ds_read_b32 v12, v13
  ds_read_b32 v17, v18 offset:4
  s_waitcnt vmcnt(23)
  s_mov_b32 s84, s86
  s_mov_b32 s85, s89
  s_mov_b32 s86, s54
  s_mov_b32 s89, s76
  s_mov_b32 s76, s80
  s_add_u32 s77, s77, 1
  s_add_u32 s78, s78, 1
  s_cmp_eq_u32 s87, 0
  s_cbranch_scc1 L_ld
  s_branch L_lsp
L_lv7_7:
  s_add_u32 m0, s76, 0
  s_add_u32 s55, s54, 0
  buffer_load_dwordx4 v22, s[32:35], s55 offen nt lds
  s_waitcnt vmcnt(24)
  s_add_u32 m0, s76, 1056
  s_add_u32 s55, s54, 1024
  buffer_load_dwordx4 v22, s[32:35], s55 offen nt lds
  s_waitcnt vmcnt(24)
  s_add_u32 m0, s76, 2112
  s_add_u32 s55, s54, 2048
  buffer_load_dwordx4 v22, s[32:35], s55 offen nt lds
  s_waitcnt vmcnt(24)
  s_add_u32 m0, s76, 3168
  s_add_u32 s55, s54, 3072
  buffer_load_dwordx4 v22, s[32:35], s55 offen nt lds
  s_waitcnt vmcnt(24)
  s_add_u32 m0, s76, 4224
  s_add_u32 s55, s54, 4096
  buffer_load_dwordx4 v22, s[32:35], s55 offen nt lds
  s_waitcnt vmcnt(24)
  s_add_u32 m0, s76, 5280
  s_add_u32 s55, s54, 5120
  buffer_load_dwordx4 v22, s[32:35], s55 offen nt lds
  s_waitcnt vmcnt(24)
  s_add_u32 m0, s76, 6336
  s_add_u32 s55, s54, 6144
  buffer_load_dwordx4 v22, s[32:35], s55 offen nt lds
  s_waitcnt vmcnt(24)
  s_add_u32 m0, s76, 7392
  s_add_u32 s55, s54, 7168
  buffer_load_dwordx4 v22, s[32:35], s55 offen nt lds
  s_add_u32 s62, s79, -2
  s_max_i32 s81, s81, s62
  v_mov_b32 v10, s81
  s_waitcnt vmcnt(24)
  ds_write_b32 v9, v10 offset:15616
  s_add_u32 m0, s85, 8448
  s_add_u32 s55, s84, 0
  buffer_load_dwordx4 v22, s[36:39], s55 offen nt lds
  s_waitcnt vmcnt(24)
  s_add_u32 m0, s85, 9504
  s_add_u32 s55, s84, 1024
  buffer_load_dwordx4 v22, s[36:39], s55 offen nt lds
  s_waitcnt vmcnt(24)
  s_add_u32 m0, s85, 10560
  s_add_u32 s55, s84, 2048
  s_add_u32 s80, s76, 16896
  v_add_u32 v14, 4, v14
  v_add_u32 v13, 4, v13
  s_cmp_eq_u32 s80, 157696
  s_cselect_b32 s80, 22528, s80
  v_and_b32 v14, 15967, v14
  buffer_load_dwordx4 v22, s[36:39], s55 offen nt lds
  s_waitcnt vmcnt(24)
  s_add_u32 m0, s85, 11616
  s_add_u32 s55, s84, 3072
  buffer_load_dwordx4 v22, s[36:39], s55 offen nt lds
  s_waitcnt vmcnt(24)
  s_add_u32 m0, s85, 12672
  s_add_u32 s55, s84, 4096
  buffer_load_dwordx4 v22, s[36:39], s55 offen nt lds
  s_waitcnt vmcnt(24)
  s_add_u32 m0, s85, 13728
  s_add_u32 s55, s84, 5120
  buffer_load_dwordx4 v22, s[36:39], s55 offen nt lds
  s_waitcnt vmcnt(24)
  s_add_u32 m0, s85, 14784
  s_add_u32 s55, s84, 6144
  buffer_load_dwordx4 v22, s[36:39], s55 offen nt lds
  s_waitcnt vmcnt(24)
  s_add_u32 m0, s85, 15840
  s_add_u32 s55, s84, 7168
  buffer_load_dwordx4 v22, s[36:39], s55 offen nt lds
  ds_read_b32 v11, v14
  ds_read_b32 v12, v13
  ds_read_b32 v17, v18 offset:4
  s_add_u32 s62, s79, -1
  s_max_i32 s81, s81, s62
  v_mov_b32 v10, s81
  s_waitcnt vmcnt(24)
  ds_write_b32 v9, v10 offset:15616
  s_mov_b32 s84, s86
  s_mov_b32 s85, s89
  s_mov_b32 s86, s54
  s_mov_b32 s89, s76
  s_mov_b32 s76, s80
  s_add_u32 s77, s77, 1
  s_add_u32 s78, s78, 1
  s_cmp_eq_u32 s87, 0
  s_cbranch_scc1 L_ld
  s_branch L_lsp
L_lv8_10:
  s_cmp_ge_u32 s83, 9
  s_cbranch_scc1 L_lv9_10
  s_add_u32 m0, s76, 0
  s_add_u32 s55, s54, 0
  buffer_load_dwordx4 v22, s[32:35], s55 offen nt lds
  s_add_u32 s62, s79, -3
  s_max_i32 s81, s81, s62
  v_mov_b32 v10, s81
  s_waitcnt vmcnt(25)
  ds_write_b32 v9, v10 offset:15616
  s_add_u32 m0, s76, 1056
  s_add_u32 s55, s54, 1024
  buffer_load_dwordx4 v22, s[32:35], s55 offen nt lds
  s_waitcnt vmcnt(25)
  s_add_u32 m0, s76, 2112
  s_add_u32 s55, s54, 2048
  buffer_load_dwordx4 v22, s[32:35], s55 offen nt lds
  s_waitcnt vmcnt(25)
  s_add_u32 m0, s76, 3168
  s_add_u32 s55, s54, 3072
  buffer_load_dwordx4 v22, s[32:35], s55 offen nt lds
  s_waitcnt vmcnt(25)
  s_add_u32 m0, s76, 4224
  s_add_u32 s55, s54, 4096
  buffer_load_dwordx4 v22, s[32:35], s55 offen nt lds
  s_waitcnt vmcnt(25)
  s_add_u32 m0, s76, 5280
  s_add_u32 s55, s54, 5120
  buffer_load_dwordx4 v22, s[32:35], s55 offen nt lds
  s_waitcnt vmcnt(25)
  s_add_u32 m0, s76, 6336
  s_add_u32 s55, s54, 6144
  buffer_load_dwordx4 v22, s[32:35], s55 offen nt lds
  s_waitcnt vmcnt(25)
  s_add_u32 m0, s76, 7392
  s_add_u32 s55, s54, 7168
  buffer_load_dwordx4 v22, s[32:35], s55 offen nt lds
  s_waitcnt vmcnt(25)
  s_add_u32 m0, s85, 8448
  s_add_u32 s55, s84, 0
  buffer_load_dwordx4 v22, s[36:39], s55 offen nt lds
  s_add_u32 s62, s79, -2
  s_max_i32 s81, s81, s62
  v_mov_b32 v10, s81
  s_waitcnt vmcnt(25)
  ds_write_b32 v9, v10 offset:15616
  s_add_u32 m0, s85, 9504
  s_add_u32 s55, s84, 1024
  buffer_load_dwordx4 v22, s[36:39], s55 offen nt lds
  s_waitcnt vmcnt(25)
  s_add_u32 m0, s85, 10560
  s_add_u32 s55, s84, 2048
  s_add_u32 s80, s76, 16896
  v_add_u32 v14, 4, v14
  v_add_u32 v13, 4, v13
  s_cmp_eq_u32 s80, 157696
  s_cselect_b32 s80, 22528, s80
  v_and_b32 v14, 15967, v14
  buffer_load_dwordx4 v22, s[36:39], s55 offen nt lds
  s_waitcnt vmcnt(25)
  s_add_u32 m0, s85, 11616
  s_add_u32 s55, s84, 3072
  buffer_load_dwordx4 v22, s[36:39], s55 offen nt lds
  s_waitcnt vmcnt(25)
  s_add_u32 m0, s85, 12672
  s_add_u32 s55, s84, 4096
  buffer_load_dwordx4 v22, s[36:39], s55 offen nt lds
  s_waitcnt vmcnt(25)
  s_add_u32 m0, s85, 13728
  s_add_u32 s55, s84, 5120
  buffer_load_dwordx4 v22, s[36:39], s55 offen nt lds
  s_waitcnt vmcnt(25)
  s_add_u32 m0, s85, 14784
  s_add_u32 s55, s84, 6144
  buffer_load_dwordx4 v22, s[36:39], s55 offen nt lds
  s_waitcnt vmcnt(25)
  s_add_u32 m0, s85, 15840
  s_add_u32 s55, s84, 7168
  buffer_load_dwordx4 v22, s[36:39], s55 offen nt lds
  ds_read_b32 v11, v14
  ds_read_b32 v12, v13
  ds_read_b32 v17, v18 offset:4
  s_waitcnt vmcnt(25)
  s_mov_b32 s84, s86
  s_mov_b32 s85, s89
  s_mov_b32 s86, s54
  s_mov_b32 s89, s76
  s_mov_b32 s76, s80
  s_add_u32 s77, s77, 1
  s_add_u32 s78, s78, 1
  s_cmp_eq_u32 s87, 0
  s_cbranch_scc1 L_ld
  s_branch L_lsp
L_lv9_10:
  s_cmp_ge_u32 s83, 10
  s_cbranch_scc1 L_lv10_10
  s_add_u32 m0, s76, 0
  s_add_u32 s55, s54, 0
  buffer_load_dwordx4 v22, s[32:35], s55 offen nt lds
  s_waitcnt vmcnt(26)
  s_add_u32 m0, s76, 1056
  s_add_u32 s55, s54, 1024
  buffer_load_dwordx4 v22, s[32:35], s55 offen nt lds
  s_add_u32 s62, s79, -3
  s_max_i32 s81, s81, s62
  v_mov_b32 v10, s81
  s_waitcnt vmcnt(26)
  ds_write_b32 v9, v10 offset:15616
  s_add_u32 m0, s76, 2112
  s_add_u32 s55, s54, 2048
  buffer_load_dwordx4 v22, s[32:35], s55 offen nt lds
  s_waitcnt vmcnt(26)
  s_add_u32 m0, s76, 3168
  s_add_u32 s55, s54, 3072
  buffer_load_dwordx4 v22, s[32:35], s55 offen nt lds
  s_waitcnt vmcnt(26)
  s_add_u32 m0, s76, 4224
  s_add_u32 s55, s54, 4096
  buffer_load_dwordx4 v22, s[32:35], s55 offen nt lds
  s_waitcnt vmcnt(26)
  s_add_u32 m0, s76, 5280
  s_add_u32 s55, s54, 5120
  buffer_load_dwordx4 v22, s[32:35], s55 offen nt lds
  s_waitcnt vmcnt(26)
  s_add_u32 m0, s76, 6336
  s_add_u32 s55, s54, 6144
  buffer_load_dwordx4 v22, s[32:35], s55 offen nt lds
  s_waitcnt vmcnt(26)
  s_add_u32 m0, s76, 7392
  s_add_u32 s55, s54, 7168
  buffer_load_dwordx4 v22, s[32:35], s55 offen nt lds
  s_waitcnt vmcnt(26)
  s_add_u32 m0, s85, 8448
  s_add_u32 s55, s84, 0
  buffer_load_dwordx4 v22, s[36:39], s55 offen nt lds
  s_waitcnt vmcnt(26)
  s_add_u32 m0, s85, 9504
  s_add_u32 s55, s84, 1024
  buffer_load_dwordx4 v22, s[36:39], s55 offen nt lds
  s_add_u32 s62, s79, -2
  s_max_i32 s81, s81, s62
  v_mov_b32 v10, s81
  s_waitcnt vmcnt(26)
  ds_write_b32 v9, v10 offset:15616
  s_add_u32 m0, s85, 10560
  s_add_u32 s55, s84, 2048
  s_add_u32 s80, s76, 16896
  v_add_u32 v14, 4, v14
  v_add_u32 v13, 4, v13
  s_cmp_eq_u32 s80, 157696
  s_cselect_b32 s80, 22528, s80
  v_and_b32 v14, 15967, v14
  buffer_load_dwordx4 v22, s[36:39], s55 offen nt lds
  s_waitcnt vmcnt(26)
  s_add_u32 m0, s85, 11616
  s_add_u32 s55, s84, 3072
  buffer_load_dwordx4 v22, s[36:39], s55 offen nt lds
  s_waitcnt vmcnt(26)
  s_add_u32 m0, s85, 12672
  s_add_u32 s55, s84, 4096
  buffer_load_dwordx4 v22, s[36:39], s55 offen nt lds
  s_waitcnt vmcnt(26)
  s_add_u32 m0, s85, 13728
  s_add_u32 s55, s84, 5120
  buffer_load_dwordx4 v22, s[36:39], s55 offen nt lds
  s_waitcnt vmcnt(26)
  s_add_u32 m0, s85, 14784
  s_add_u32 s55, s84, 6144
  buffer_load_dwordx4 v22, s[36:39], s55 offen nt lds
  s_waitcnt vmcnt(26)
  s_add_u32 m0, s85, 15840
  s_add_u32 s55, s84, 7168
  buffer_load_dwordx4 v22, s[36:39], s55 offen nt lds
  ds_read_b32 v11, v14
  ds_read_b32 v12, v13
  ds_read_b32 v17, v18 offset:4
  s_waitcnt vmcnt(26)
  s_mov_b32 s84, s86
  s_mov_b32 s85, s89
  s_mov_b32 s86, s54
  s_mov_b32 s89, s76
  s_mov_b32 s76, s80
  s_add_u32 s77, s77, 1
  s_add_u32 s78, s78, 1
  s_cmp_eq_u32 s87, 0
  s_cbranch_scc1 L_ld
  s_branch L_lsp
L_lv10_10:
  s_add_u32 m0, s76, 0
  s_add_u32 s55, s54, 0
  buffer_load_dwordx4 v22, s[32:35], s55 offen nt lds
  s_waitcnt vmcnt(27)
  s_add_u32 m0, s76, 1056
  s_add_u32 s55, s54, 1024
  buffer_load_dwordx4 v22, s[32:35], s55 offen nt lds
  s_waitcnt vmcnt(27)
  s_add_u32 m0, s76, 2112
  s_add_u32 s55, s54, 2048
  buffer_load_dwordx4 v22, s[32:35], s55 offen nt lds
  s_add_u32 s62, s79, -3
  s_max_i32 s81, s81, s62
  v_mov_b32 v10, s81
  s_waitcnt vmcnt(27)
  ds_write_b32 v9, v10 offset:15616
  s_add_u32 m0, s76, 3168
  s_add_u32 s55, s54, 3072
  buffer_load_dwordx4 v22, s[32:35], s55 offen nt lds
  s_waitcnt vmcnt(27)
  s_add_u32 m0, s76, 4224
  s_add_u32 s55, s54, 4096
  buffer_load_dwordx4 v22, s[32:35], s55 offen nt lds
  s_waitcnt vmcnt(27)
  s_add_u32 m0, s76, 5280
  s_add_u32 s55, s54, 5120
  buffer_load_dwordx4 v22, s[32:35], s55 offen nt lds
  s_waitcnt vmcnt(27)
  s_add_u32 m0, s76, 6336
  s_add_u32 s55, s54, 6144
  buffer_load_dwordx4 v22, s[32:35], s55 offen nt lds
  s_waitcnt vmcnt(27)
  s_add_u32 m0, s76, 7392
  s_add_u32 s55, s54, 7168
  buffer_load_dwordx4 v22, s[32:35], s55 offen nt lds
  s_waitcnt vmcnt(27)
  s_add_u32 m0, s85, 8448
  s_add_u32 s55, s84, 0
  buffer_load_dwordx4 v22, s[36:39], s55 offen nt lds
  s_waitcnt vmcnt(27)
  s_add_u32 m0, s85, 9504
  s_add_u32 s55, s84, 1024
  buffer_load_dwordx4 v22, s[36:39], s55 offen nt lds
  s_waitcnt vmcnt(27)
  s_add_u32 m0, s85, 10560
  s_add_u32 s55, s84, 2048
  s_add_u32 s80, s76, 16896
  v_add_u32 v14, 4, v14
  v_add_u32 v13, 4, v13
  s_cmp_eq_u32 s80, 157696
  s_cselect_b32 s80, 22528, s80
  v_and_b32 v14, 15967, v14
  buffer_load_dwordx4 v22, s[36:39], s55 offen nt lds
  s_add_u32 s62, s79, -2
  s_max_i32 s81, s81, s62
  v_mov_b32 v10, s81
  s_waitcnt vmcnt(27)
  ds_write_b32 v9, v10 offset:15616
  s_add_u32 m0, s85, 11616
  s_add_u32 s55, s84, 3072
  buffer_load_dwordx4 v22, s[36:39], s55 offen nt lds
  s_waitcnt vmcnt(27)
  s_add_u32 m0, s85, 12672
  s_add_u32 s55, s84, 4096
  buffer_load_dwordx4 v22, s[36:39], s55 offen nt lds
  s_waitcnt vmcnt(27)
  s_add_u32 m0, s85, 13728
  s_add_u32 s55, s84, 5120
  buffer_load_dwordx4 v22, s[36:39], s55 offen nt lds
  s_waitcnt vmcnt(27)
  s_add_u32 m0, s85, 14784
  s_add_u32 s55, s84, 6144
  buffer_load_dwordx4 v22, s[36:39], s55 offen nt lds
  s_waitcnt vmcnt(27)
  s_add_u32 m0, s85, 15840
  s_add_u32 s55, s84, 7168
  buffer_load_dwordx4 v22, s[36:39], s55 offen nt lds
  ds_read_b32 v11, v14
  ds_read_b32 v12, v13
  ds_read_b32 v17, v18 offset:4
  s_waitcnt vmcnt(27)
  s_mov_b32 s84, s86
  s_mov_b32 s85, s89
  s_mov_b32 s86, s54
  s_mov_b32 s89, s76
  s_mov_b32 s76, s80
  s_add_u32 s77, s77, 1
  s_add_u32 s78, s78, 1
  s_cmp_eq_u32 s87, 0
  s_cbranch_scc1 L_ld
  s_branch L_lsp
.section .rodata,"a"
.p2align 6
.amdhsa_kernel adaLN_cond__gqa_block_cached__geglu_ffn__decode_kernel
  .amdhsa_next_free_vgpr 256
  .amdhsa_next_free_sgpr 102
  .amdhsa_accum_offset 256
  .amdhsa_group_segment_fixed_size 0
  .amdhsa_kernarg_size 112
  .amdhsa_user_sgpr_count 2
  .amdhsa_user_sgpr_kernarg_segment_ptr 1
  .amdhsa_system_sgpr_workgroup_id_x 1
  .amdhsa_float_denorm_mode_32 3
.end_amdhsa_kernel
```
